```python
import torch

def _softmax(x, axis=-1):
    return torch.softmax(x, dim=axis)
def _gelu(x):
    return torch.nn.functional.gelu(x, approximate="tanh")
def _silu(x):
    return torch.nn.functional.silu(x)
def _sigmoid(x):
    return torch.sigmoid(x)
def _layernorm(x, axis=-1, eps=1e-5):
    m = x.mean(dim=axis, keepdim=True)
    v = x.var(dim=axis, keepdim=True, unbiased=False)
    return (x - m) / torch.sqrt(v + eps)
def _scatter_add(tgt, idx, src, axis=0):
    return tgt.clone().index_add_(axis, idx, src)
def _segment_sum(src, seg, n):
    out = torch.zeros((n,) + src.shape[1:], dtype=src.dtype)
    return out.index_add_(0, seg, src)
def _pad(x, pw):
    flat = tuple(v for pair in reversed(pw) for v in pair)
    return torch.nn.functional.pad(x, flat)

kernel_name = 'recurrent_scan__sliding_local_dilated__dense_activation_relu__prompt'

def setup_inputs():

    _w = (lambda a: (lambda t: t.to(torch.bfloat16) if t.is_floating_point() else t)(torch.as_tensor(a)))
    def _A_setup():
        B, S, D = 1, 2048, 576
        return {
            "x": _w((lambda *s: torch.randn(*s, dtype=torch.bfloat16) * 0.05)(B, S, D)),
            "wqkv": _w((lambda *s: torch.randn(*s, dtype=torch.bfloat16) * 0.05)(D, 3 * D)),
            "wo": _w((lambda *s: torch.randn(*s, dtype=torch.bfloat16) * 0.05)(D, D)),
        }
    _A_in = _A_setup()

    def _B_setup():
        B, S, D, Dff = 1, 2048, 576, 4608
        return {
            "x": _w((lambda *s: torch.randn(*s, dtype=torch.bfloat16) * 0.05)(B, S, D)),
            "w1": _w((lambda *s: torch.randn(*s, dtype=torch.bfloat16) * 0.05)(D, Dff)),
            "w2": _w((lambda *s: torch.randn(*s, dtype=torch.bfloat16) * 0.05)(Dff, D)),
        }
    _B_in = _B_setup()

    return {
        "A_x": _A_in["x"],
        "A_wqkv": _A_in["wqkv"],
        "A_wo": _A_in["wo"],
        "B_x": _B_in["x"],
        "B_w1": _B_in["w1"],
        "B_w2": _B_in["w2"],
    }

def reference(A_x, A_wqkv, A_wo, B_x, B_w1, B_w2):
    def _A_ref(x, wqkv, wo):
        B, S, D = x.shape
        H = 32; Dh = D // H
        W, dil = 8, 2
        qkv = (lambda x, *d: x.permute(*d))((x @ wqkv).reshape(B, S, 3, H, Dh), 2, 0, 3, 1, 4)
        q, k, v = qkv[0], qkv[1], qkv[2]
        scale = Dh ** -0.5
        pos = torch.arange(S)
        off = torch.arange(W) * dil
        idx = pos[:, None] - off[None, :]
        mask = idx >= 0
        idx_c = torch.where(mask, idx, 0).reshape(-1)
        kg = k[:, :, idx_c, :].reshape(B, H, S, W, Dh)
        vg = v[:, :, idx_c, :].reshape(B, H, S, W, Dh)
        logits = torch.einsum("bhsd,bhswd->bhsw", q, kg) * scale
        logits = torch.where(mask[None, None, :, :], logits, -1e9)
        attn = _softmax(logits, axis=-1)
        o = torch.einsum("bhsw,bhswd->bhsd", attn, vg)
        return (lambda x, *d: x.permute(*d))(o, 0, 2, 1, 3).reshape(B, S, D) @ wo

    def _B_ref(x, w1, w2):
        h = torch.einsum("bsd,df->bsf", x, w1)
        zero = torch.zeros_like(h)
        h = torch.maximum(h, zero)
        return torch.einsum("bsf,fd->bsd", h, w2)

    x = A_x
    xn = _layernorm(x, axis=-1)
    s = _A_ref(xn, A_wqkv, A_wo)
    g = _silu(_B_ref(xn, B_w1, B_w2))
    return x + s * g
```

```asm
; @launch kernel=k0_kernel grid=(256,1,1) block=(256,1,1) lds=0
; @launch kernel=k1_kernel grid=(256,1,1) block=(512,1,1) lds=159744
.amdgcn_target "amdgcn-amd-amdhsa--gfx950"
.text
.globl k0_kernel
.p2align 8
.type k0_kernel,@function
k0_kernel:
    s_cmp_ge_u32 s2, 256
    s_cbranch_scc1 K0_END
    s_load_dwordx4 s[48:51], s[0:1], 0
    s_load_dwordx2 s[52:53], s[0:1], 16
    s_load_dwordx2 s[54:55], s[0:1], 64
    s_load_dwordx2 s[34:35], s[0:1], 32
    v_lshrrev_b32 v1, 7, v0
    v_and_b32 v2, 127, v0
    s_nop 0
    v_readfirstlane_b32 s33, v1
    s_waitcnt lgkmcnt(0)
    s_mov_b32 s8, s48
    s_mov_b32 s9, s49
    s_mov_b32 s10, 0x240000
    s_mov_b32 s11, 0x00020000
    s_mov_b32 s16, s50
    s_mov_b32 s17, s51
    s_mov_b32 s18, 0x1e6000
    s_mov_b32 s19, 0x00020000
    s_mov_b32 s24, s52
    s_mov_b32 s25, s53
    s_mov_b32 s26, 0xa2000
    s_mov_b32 s27, 0x00020000
    s_add_u32 s12, s54, 0x1440000
    s_addc_u32 s13, s55, 0
    s_mov_b32 s14, 0x240000
    s_mov_b32 s15, 0x00020000
    s_add_u32 s20, s54, 0x1680000
    s_addc_u32 s21, s55, 0
    s_mov_b32 s22, 0x240000
    s_mov_b32 s23, 0x00020000
    s_add_u32 s28, s54, 0x18c0000
    s_addc_u32 s29, s55, 0
    s_mov_b32 s30, 0xa2000
    s_mov_b32 s31, 0x00020000
    s_cmp_eq_u32 s33, 0
    s_cbranch_scc0 K0_PACK
    s_lshl_b32 s40, s2, 3
    v_lshrrev_b32 v3, 4, v2
    v_add_u32 v3, s40, v3
    v_and_b32 v4, 15, v2
    v_mul_u32_u24 v5, 1152, v3
    v_lshl_add_u32 v5, v4, 3, v5
    buffer_load_dwordx2 v[10:11], v5, s[8:11], 0 offen offset:0
    buffer_load_dwordx2 v[12:13], v5, s[8:11], 0 offen offset:128
    buffer_load_dwordx2 v[14:15], v5, s[8:11], 0 offen offset:256
    buffer_load_dwordx2 v[16:17], v5, s[8:11], 0 offen offset:384
    buffer_load_dwordx2 v[18:19], v5, s[8:11], 0 offen offset:512
    buffer_load_dwordx2 v[20:21], v5, s[8:11], 0 offen offset:640
    buffer_load_dwordx2 v[22:23], v5, s[8:11], 0 offen offset:768
    buffer_load_dwordx2 v[24:25], v5, s[8:11], 0 offen offset:896
    buffer_load_dwordx2 v[26:27], v5, s[8:11], 0 offen offset:1024
    s_mov_b32 s36, s34
    s_mov_b32 s37, s35
    s_mov_b32 s38, 0x510000
    s_mov_b32 s39, 0x00020000
    s_getpc_b64 s[56:57]
K0_PC60:
    v_lshrrev_b32 v72, 6, v0
    s_lshr_b32 s58, s2, 3
    s_lshl_b32 s58, s58, 2
    v_readfirstlane_b32 s59, v72
    s_add_u32 s58, s58, s59
    s_mul_i32 s58, s58, 320
    s_min_u32 s58, s58, K1_LAST-k1_kernel-320
    s_add_u32 s58, s58, k1_kernel-K0_PC60
    s_add_u32 s56, s56, s58
    s_addc_u32 s57, s57, 0
    s_load_dword s60, s[56:57], 0
    s_load_dword s60, s[56:57], 64
    s_load_dword s60, s[56:57], 128
    s_load_dword s60, s[56:57], 192
    s_load_dword s60, s[56:57], 256
    s_lshr_b32 s44, s2, 3
    s_mul_i32 s44, s44, 165888
    s_and_b32 s45, s2, 7
    s_mul_i32 s45, s45, 1152
    s_add_u32 s44, s44, s45
    v_add_u32 v72, 0, v0
    v_min_u32 v72, 323, v72
    v_mul_u32_u24 v73, 3641, v72
    v_lshrrev_b32 v73, 16, v73
    v_mul_u32_u24 v74, 18, v73
    v_sub_u32 v74, v72, v74
    v_mul_u32_u24 v73, 9216, v73
    v_lshl_add_u32 v73, v74, 6, v73
    buffer_load_dword v75, v73, s[36:39], s44 offen
    v_add_u32 v72, 256, v0
    v_min_u32 v72, 323, v72
    v_mul_u32_u24 v73, 3641, v72
    v_lshrrev_b32 v73, 16, v73
    v_mul_u32_u24 v74, 18, v73
    v_sub_u32 v74, v72, v74
    v_mul_u32_u24 v73, 9216, v73
    v_lshl_add_u32 v73, v74, 6, v73
    buffer_load_dword v75, v73, s[36:39], s44 offen
    v_lshrrev_b32 v6, 4, v3
    v_lshrrev_b32 v7, 3, v4
    v_lshl_add_u32 v6, v7, 7, v6
    v_lshlrev_b32 v6, 10, v6
    v_and_b32 v7, 3, v4
    v_lshl_add_u32 v6, v7, 8, v6
    v_and_b32 v7, 15, v3
    v_lshl_add_u32 v6, v7, 4, v6
    v_bfe_u32 v7, v4, 2, 1
    v_lshl_add_u32 v6, v7, 3, v6
    s_mov_b32 s40, 0x3ae38e39
    s_mov_b32 s41, 0x3727c5ac
    v_mov_b32 v8, 0
    s_waitcnt vmcnt(10)
    v_lshlrev_b32 v32, 16, v10
    v_and_b32 v33, 0xffff0000, v10
    v_add_f32 v8, v8, v32
    v_add_f32 v8, v8, v33
    v_lshlrev_b32 v34, 16, v11
    v_and_b32 v35, 0xffff0000, v11
    v_add_f32 v8, v8, v34
    v_add_f32 v8, v8, v35
    s_waitcnt vmcnt(9)
    v_lshlrev_b32 v36, 16, v12
    v_and_b32 v37, 0xffff0000, v12
    v_add_f32 v8, v8, v36
    v_add_f32 v8, v8, v37
    v_lshlrev_b32 v38, 16, v13
    v_and_b32 v39, 0xffff0000, v13
    v_add_f32 v8, v8, v38
    v_add_f32 v8, v8, v39
    s_waitcnt vmcnt(8)
    v_lshlrev_b32 v40, 16, v14
    v_and_b32 v41, 0xffff0000, v14
    v_add_f32 v8, v8, v40
    v_add_f32 v8, v8, v41
    v_lshlrev_b32 v42, 16, v15
    v_and_b32 v43, 0xffff0000, v15
    v_add_f32 v8, v8, v42
    v_add_f32 v8, v8, v43
    s_waitcnt vmcnt(7)
    v_lshlrev_b32 v44, 16, v16
    v_and_b32 v45, 0xffff0000, v16
    v_add_f32 v8, v8, v44
    v_add_f32 v8, v8, v45
    v_lshlrev_b32 v46, 16, v17
    v_and_b32 v47, 0xffff0000, v17
    v_add_f32 v8, v8, v46
    v_add_f32 v8, v8, v47
    s_waitcnt vmcnt(6)
    v_lshlrev_b32 v48, 16, v18
    v_and_b32 v49, 0xffff0000, v18
    v_add_f32 v8, v8, v48
    v_add_f32 v8, v8, v49
    v_lshlrev_b32 v50, 16, v19
    v_and_b32 v51, 0xffff0000, v19
    v_add_f32 v8, v8, v50
    v_add_f32 v8, v8, v51
    s_waitcnt vmcnt(5)
    v_lshlrev_b32 v52, 16, v20
    v_and_b32 v53, 0xffff0000, v20
    v_add_f32 v8, v8, v52
    v_add_f32 v8, v8, v53
    v_lshlrev_b32 v54, 16, v21
    v_and_b32 v55, 0xffff0000, v21
    v_add_f32 v8, v8, v54
    v_add_f32 v8, v8, v55
    s_waitcnt vmcnt(4)
    v_lshlrev_b32 v56, 16, v22
    v_and_b32 v57, 0xffff0000, v22
    v_add_f32 v8, v8, v56
    v_add_f32 v8, v8, v57
    v_lshlrev_b32 v58, 16, v23
    v_and_b32 v59, 0xffff0000, v23
    v_add_f32 v8, v8, v58
    v_add_f32 v8, v8, v59
    s_waitcnt vmcnt(3)
    v_lshlrev_b32 v60, 16, v24
    v_and_b32 v61, 0xffff0000, v24
    v_add_f32 v8, v8, v60
    v_add_f32 v8, v8, v61
    v_lshlrev_b32 v62, 16, v25
    v_and_b32 v63, 0xffff0000, v25
    v_add_f32 v8, v8, v62
    v_add_f32 v8, v8, v63
    s_waitcnt vmcnt(2)
    v_lshlrev_b32 v64, 16, v26
    v_and_b32 v65, 0xffff0000, v26
    v_add_f32 v8, v8, v64
    v_add_f32 v8, v8, v65
    v_lshlrev_b32 v66, 16, v27
    v_and_b32 v67, 0xffff0000, v27
    v_add_f32 v8, v8, v66
    v_add_f32 v8, v8, v67
    s_nop 1
    v_add_f32_dpp v8, v8, v8 row_ror:8 row_mask:0xf bank_mask:0xf
    s_nop 1
    v_add_f32_dpp v8, v8, v8 row_ror:4 row_mask:0xf bank_mask:0xf
    s_nop 1
    v_add_f32_dpp v8, v8, v8 row_ror:2 row_mask:0xf bank_mask:0xf
    s_nop 1
    v_add_f32_dpp v8, v8, v8 row_ror:1 row_mask:0xf bank_mask:0xf
    v_mul_f32 v8, s40, v8
    v_cvt_pk_bf16_f32 v9, v8, v8
    v_and_b32 v9, 0xffff0000, v9
    v_mov_b32 v70, 0
    v_sub_f32 v71, v32, v8
    v_fmac_f32 v70, v71, v71
    v_sub_f32 v71, v33, v8
    v_fmac_f32 v70, v71, v71
    v_sub_f32 v71, v34, v8
    v_fmac_f32 v70, v71, v71
    v_sub_f32 v71, v35, v8
    v_fmac_f32 v70, v71, v71
    v_sub_f32 v71, v36, v8
    v_fmac_f32 v70, v71, v71
    v_sub_f32 v71, v37, v8
    v_fmac_f32 v70, v71, v71
    v_sub_f32 v71, v38, v8
    v_fmac_f32 v70, v71, v71
    v_sub_f32 v71, v39, v8
    v_fmac_f32 v70, v71, v71
    v_sub_f32 v71, v40, v8
    v_fmac_f32 v70, v71, v71
    v_sub_f32 v71, v41, v8
    v_fmac_f32 v70, v71, v71
    v_sub_f32 v71, v42, v8
    v_fmac_f32 v70, v71, v71
    v_sub_f32 v71, v43, v8
    v_fmac_f32 v70, v71, v71
    v_sub_f32 v71, v44, v8
    v_fmac_f32 v70, v71, v71
    v_sub_f32 v71, v45, v8
    v_fmac_f32 v70, v71, v71
    v_sub_f32 v71, v46, v8
    v_fmac_f32 v70, v71, v71
    v_sub_f32 v71, v47, v8
    v_fmac_f32 v70, v71, v71
    v_sub_f32 v71, v48, v8
    v_fmac_f32 v70, v71, v71
    v_sub_f32 v71, v49, v8
    v_fmac_f32 v70, v71, v71
    v_sub_f32 v71, v50, v8
    v_fmac_f32 v70, v71, v71
    v_sub_f32 v71, v51, v8
    v_fmac_f32 v70, v71, v71
    v_sub_f32 v71, v52, v8
    v_fmac_f32 v70, v71, v71
    v_sub_f32 v71, v53, v8
    v_fmac_f32 v70, v71, v71
    v_sub_f32 v71, v54, v8
    v_fmac_f32 v70, v71, v71
    v_sub_f32 v71, v55, v8
    v_fmac_f32 v70, v71, v71
    v_sub_f32 v71, v56, v8
    v_fmac_f32 v70, v71, v71
    v_sub_f32 v71, v57, v8
    v_fmac_f32 v70, v71, v71
    v_sub_f32 v71, v58, v8
    v_fmac_f32 v70, v71, v71
    v_sub_f32 v71, v59, v8
    v_fmac_f32 v70, v71, v71
    v_sub_f32 v71, v60, v8
    v_fmac_f32 v70, v71, v71
    v_sub_f32 v71, v61, v8
    v_fmac_f32 v70, v71, v71
    v_sub_f32 v71, v62, v8
    v_fmac_f32 v70, v71, v71
    v_sub_f32 v71, v63, v8
    v_fmac_f32 v70, v71, v71
    v_sub_f32 v71, v64, v8
    v_fmac_f32 v70, v71, v71
    v_sub_f32 v71, v65, v8
    v_fmac_f32 v70, v71, v71
    v_sub_f32 v71, v66, v8
    v_fmac_f32 v70, v71, v71
    v_sub_f32 v71, v67, v8
    v_fmac_f32 v70, v71, v71
    s_nop 1
    v_add_f32_dpp v70, v70, v70 row_ror:8 row_mask:0xf bank_mask:0xf
    s_nop 1
    v_add_f32_dpp v70, v70, v70 row_ror:4 row_mask:0xf bank_mask:0xf
    s_nop 1
    v_add_f32_dpp v70, v70, v70 row_ror:2 row_mask:0xf bank_mask:0xf
    s_nop 1
    v_add_f32_dpp v70, v70, v70 row_ror:1 row_mask:0xf bank_mask:0xf
    v_mul_f32 v70, s40, v70
    v_cvt_pk_bf16_f32 v70, v70, v70
    v_and_b32 v70, 0xffff0000, v70
    v_add_f32 v70, s41, v70
    v_cvt_pk_bf16_f32 v70, v70, v70
    v_and_b32 v70, 0xffff0000, v70
    v_sqrt_f32 v70, v70
    s_nop 0
    v_cvt_pk_bf16_f32 v70, v70, v70
    v_and_b32 v70, 0xffff0000, v70
    v_rcp_f32 v70, v70
    v_sub_f32 v32, v32, v9
    v_sub_f32 v33, v33, v9
    v_cvt_pk_bf16_f32 v32, v32, v33
    v_and_b32 v33, 0xffff0000, v32
    v_lshlrev_b32 v32, 16, v32
    v_mul_f32 v32, v32, v70
    v_mul_f32 v33, v33, v70
    v_cvt_pk_bf16_f32 v10, v32, v33
    v_sub_f32 v34, v34, v9
    v_sub_f32 v35, v35, v9
    v_cvt_pk_bf16_f32 v34, v34, v35
    v_and_b32 v35, 0xffff0000, v34
    v_lshlrev_b32 v34, 16, v34
    v_mul_f32 v34, v34, v70
    v_mul_f32 v35, v35, v70
    v_cvt_pk_bf16_f32 v11, v34, v35
    s_mov_b32 s42, 0
    buffer_store_dwordx2 v[10:11], v6, s[12:15], s42 offen
    v_sub_f32 v36, v36, v9
    v_sub_f32 v37, v37, v9
    v_cvt_pk_bf16_f32 v36, v36, v37
    v_and_b32 v37, 0xffff0000, v36
    v_lshlrev_b32 v36, 16, v36
    v_mul_f32 v36, v36, v70
    v_mul_f32 v37, v37, v70
    v_cvt_pk_bf16_f32 v12, v36, v37
    v_sub_f32 v38, v38, v9
    v_sub_f32 v39, v39, v9
    v_cvt_pk_bf16_f32 v38, v38, v39
    v_and_b32 v39, 0xffff0000, v38
    v_lshlrev_b32 v38, 16, v38
    v_mul_f32 v38, v38, v70
    v_mul_f32 v39, v39, v70
    v_cvt_pk_bf16_f32 v13, v38, v39
    s_mov_b32 s42, 262144
    buffer_store_dwordx2 v[12:13], v6, s[12:15], s42 offen
    v_sub_f32 v40, v40, v9
    v_sub_f32 v41, v41, v9
    v_cvt_pk_bf16_f32 v40, v40, v41
    v_and_b32 v41, 0xffff0000, v40
    v_lshlrev_b32 v40, 16, v40
    v_mul_f32 v40, v40, v70
    v_mul_f32 v41, v41, v70
    v_cvt_pk_bf16_f32 v14, v40, v41
    v_sub_f32 v42, v42, v9
    v_sub_f32 v43, v43, v9
    v_cvt_pk_bf16_f32 v42, v42, v43
    v_and_b32 v43, 0xffff0000, v42
    v_lshlrev_b32 v42, 16, v42
    v_mul_f32 v42, v42, v70
    v_mul_f32 v43, v43, v70
    v_cvt_pk_bf16_f32 v15, v42, v43
    s_mov_b32 s42, 524288
    buffer_store_dwordx2 v[14:15], v6, s[12:15], s42 offen
    v_sub_f32 v44, v44, v9
    v_sub_f32 v45, v45, v9
    v_cvt_pk_bf16_f32 v44, v44, v45
    v_and_b32 v45, 0xffff0000, v44
    v_lshlrev_b32 v44, 16, v44
    v_mul_f32 v44, v44, v70
    v_mul_f32 v45, v45, v70
    v_cvt_pk_bf16_f32 v16, v44, v45
    v_sub_f32 v46, v46, v9
    v_sub_f32 v47, v47, v9
    v_cvt_pk_bf16_f32 v46, v46, v47
    v_and_b32 v47, 0xffff0000, v46
    v_lshlrev_b32 v46, 16, v46
    v_mul_f32 v46, v46, v70
    v_mul_f32 v47, v47, v70
    v_cvt_pk_bf16_f32 v17, v46, v47
    s_mov_b32 s42, 786432
    buffer_store_dwordx2 v[16:17], v6, s[12:15], s42 offen
    v_sub_f32 v48, v48, v9
    v_sub_f32 v49, v49, v9
    v_cvt_pk_bf16_f32 v48, v48, v49
    v_and_b32 v49, 0xffff0000, v48
    v_lshlrev_b32 v48, 16, v48
    v_mul_f32 v48, v48, v70
    v_mul_f32 v49, v49, v70
    v_cvt_pk_bf16_f32 v18, v48, v49
    v_sub_f32 v50, v50, v9
    v_sub_f32 v51, v51, v9
    v_cvt_pk_bf16_f32 v50, v50, v51
    v_and_b32 v51, 0xffff0000, v50
    v_lshlrev_b32 v50, 16, v50
    v_mul_f32 v50, v50, v70
    v_mul_f32 v51, v51, v70
    v_cvt_pk_bf16_f32 v19, v50, v51
    s_mov_b32 s42, 1048576
    buffer_store_dwordx2 v[18:19], v6, s[12:15], s42 offen
    v_sub_f32 v52, v52, v9
    v_sub_f32 v53, v53, v9
    v_cvt_pk_bf16_f32 v52, v52, v53
    v_and_b32 v53, 0xffff0000, v52
    v_lshlrev_b32 v52, 16, v52
    v_mul_f32 v52, v52, v70
    v_mul_f32 v53, v53, v70
    v_cvt_pk_bf16_f32 v20, v52, v53
    v_sub_f32 v54, v54, v9
    v_sub_f32 v55, v55, v9
    v_cvt_pk_bf16_f32 v54, v54, v55
    v_and_b32 v55, 0xffff0000, v54
    v_lshlrev_b32 v54, 16, v54
    v_mul_f32 v54, v54, v70
    v_mul_f32 v55, v55, v70
    v_cvt_pk_bf16_f32 v21, v54, v55
    s_mov_b32 s42, 1310720
    buffer_store_dwordx2 v[20:21], v6, s[12:15], s42 offen
    v_sub_f32 v56, v56, v9
    v_sub_f32 v57, v57, v9
    v_cvt_pk_bf16_f32 v56, v56, v57
    v_and_b32 v57, 0xffff0000, v56
    v_lshlrev_b32 v56, 16, v56
    v_mul_f32 v56, v56, v70
    v_mul_f32 v57, v57, v70
    v_cvt_pk_bf16_f32 v22, v56, v57
    v_sub_f32 v58, v58, v9
    v_sub_f32 v59, v59, v9
    v_cvt_pk_bf16_f32 v58, v58, v59
    v_and_b32 v59, 0xffff0000, v58
    v_lshlrev_b32 v58, 16, v58
    v_mul_f32 v58, v58, v70
    v_mul_f32 v59, v59, v70
    v_cvt_pk_bf16_f32 v23, v58, v59
    s_mov_b32 s42, 1572864
    buffer_store_dwordx2 v[22:23], v6, s[12:15], s42 offen
    v_sub_f32 v60, v60, v9
    v_sub_f32 v61, v61, v9
    v_cvt_pk_bf16_f32 v60, v60, v61
    v_and_b32 v61, 0xffff0000, v60
    v_lshlrev_b32 v60, 16, v60
    v_mul_f32 v60, v60, v70
    v_mul_f32 v61, v61, v70
    v_cvt_pk_bf16_f32 v24, v60, v61
    v_sub_f32 v62, v62, v9
    v_sub_f32 v63, v63, v9
    v_cvt_pk_bf16_f32 v62, v62, v63
    v_and_b32 v63, 0xffff0000, v62
    v_lshlrev_b32 v62, 16, v62
    v_mul_f32 v62, v62, v70
    v_mul_f32 v63, v63, v70
    v_cvt_pk_bf16_f32 v25, v62, v63
    s_mov_b32 s42, 1835008
    buffer_store_dwordx2 v[24:25], v6, s[12:15], s42 offen
    v_sub_f32 v64, v64, v9
    v_sub_f32 v65, v65, v9
    v_cvt_pk_bf16_f32 v64, v64, v65
    v_and_b32 v65, 0xffff0000, v64
    v_lshlrev_b32 v64, 16, v64
    v_mul_f32 v64, v64, v70
    v_mul_f32 v65, v65, v70
    v_cvt_pk_bf16_f32 v26, v64, v65
    v_sub_f32 v66, v66, v9
    v_sub_f32 v67, v67, v9
    v_cvt_pk_bf16_f32 v66, v66, v67
    v_and_b32 v67, 0xffff0000, v66
    v_lshlrev_b32 v66, 16, v66
    v_mul_f32 v66, v66, v70
    v_mul_f32 v67, v67, v70
    v_cvt_pk_bf16_f32 v27, v66, v67
    s_mov_b32 s42, 2097152
    buffer_store_dwordx2 v[26:27], v6, s[12:15], s42 offen
    s_endpgm
K0_PACK:
    s_lshr_b32 s40, s2, 3
    s_and_b32 s41, s2, 7
    s_mul_i32 s41, s41, 72
    s_mul_i32 s40, s40, 36
    v_lshrrev_b32 v3, 5, v2
    v_add_u32 v3, s41, v3
    v_mul_u32_u24 v3, 3456, v3
    v_and_b32 v4, 31, v2
    v_lshrrev_b32 v5, 3, v4
    v_and_b32 v6, 7, v4
    v_min_u32 v7, 2, v6
    v_cmp_eq_u32 vcc, 3, v5
    s_nop 1
    v_cndmask_b32 v5, v5, v7, vcc
    v_cndmask_b32 v6, v6, 8, vcc
    v_mul_u32_u24 v5, 1152, v5
    v_lshl_add_u32 v5, v6, 2, v5
    v_add3_u32 v3, v3, v5, s40
    s_mul_i32 s42, s2, 9216
    v_lshlrev_b32 v4, 2, v2
    v_add_u32 v4, s42, v4
    s_mov_b32 s43, 0
    buffer_load_dword v10, v3, s[16:19], s43 offen
    s_mov_b32 s43, 13824
    buffer_load_dword v11, v3, s[16:19], s43 offen
    s_mov_b32 s43, 27648
    buffer_load_dword v12, v3, s[16:19], s43 offen
    s_mov_b32 s43, 41472
    buffer_load_dword v13, v3, s[16:19], s43 offen
    s_mov_b32 s43, 55296
    buffer_load_dword v14, v3, s[16:19], s43 offen
    s_mov_b32 s43, 69120
    buffer_load_dword v15, v3, s[16:19], s43 offen
    s_mov_b32 s43, 82944
    buffer_load_dword v16, v3, s[16:19], s43 offen
    s_mov_b32 s43, 96768
    buffer_load_dword v17, v3, s[16:19], s43 offen
    s_mov_b32 s43, 110592
    buffer_load_dword v18, v3, s[16:19], s43 offen
    s_mov_b32 s43, 124416
    buffer_load_dword v19, v3, s[16:19], s43 offen
    s_mov_b32 s43, 138240
    buffer_load_dword v20, v3, s[16:19], s43 offen
    s_mov_b32 s43, 152064
    buffer_load_dword v21, v3, s[16:19], s43 offen
    s_mov_b32 s43, 165888
    buffer_load_dword v22, v3, s[16:19], s43 offen
    s_mov_b32 s43, 179712
    buffer_load_dword v23, v3, s[16:19], s43 offen
    s_mov_b32 s43, 193536
    buffer_load_dword v24, v3, s[16:19], s43 offen
    s_mov_b32 s43, 207360
    buffer_load_dword v25, v3, s[16:19], s43 offen
    s_mov_b32 s43, 221184
    buffer_load_dword v26, v3, s[16:19], s43 offen
    s_mov_b32 s43, 235008
    buffer_load_dword v27, v3, s[16:19], s43 offen
    s_mul_i32 s40, s2, 162
    v_add_u32 v40, s40, v2
    s_mov_b32 s41, 59652324
    v_mul_hi_u32 v41, v40, s41
    v_mul_u32_u24 v42, 72, v41
    v_sub_u32 v42, v40, v42
    v_mov_b32 v44, v41
    v_lshrrev_b32 v45, 4, v44
    v_mul_u32_u24 v45, 18, v45
    v_and_b32 v46, 15, v44
    v_add_u32 v45, v45, v46
    v_bfe_u32 v46, v44, 1, 5
    v_mul_u32_u24 v46, 18, v46
    v_and_b32 v47, 1, v44
    v_add3_u32 v46, v46, v47, 16
    v_cmp_gt_u32 vcc, 512, v44
    s_nop 1
    v_cndmask_b32 v45, v46, v45, vcc
    v_mul_u32_u24 v45, 1152, v45
    v_lshl_add_u32 v45, v42, 4, v45
    v_lshlrev_b32 v40, 4, v40
    buffer_load_dwordx4 v[48:51], v45, s[24:27], 0 offen
    v_add_u32 v52, s40, v2
    v_add_u32 v52, 128, v52
    s_mov_b32 s41, 59652324
    v_mul_hi_u32 v53, v52, s41
    v_mul_u32_u24 v54, 72, v53
    v_sub_u32 v54, v52, v54
    v_mov_b32 v56, v53
    v_lshrrev_b32 v57, 4, v56
    v_mul_u32_u24 v57, 18, v57
    v_and_b32 v58, 15, v56
    v_add_u32 v57, v57, v58
    v_bfe_u32 v58, v56, 1, 5
    v_mul_u32_u24 v58, 18, v58
    v_and_b32 v59, 1, v56
    v_add3_u32 v58, v58, v59, 16
    v_cmp_gt_u32 vcc, 512, v56
    s_nop 1
    v_cndmask_b32 v57, v58, v57, vcc
    v_mul_u32_u24 v57, 1152, v57
    v_lshl_add_u32 v57, v54, 4, v57
    v_lshlrev_b32 v52, 4, v52
    v_mov_b32 v59, 0x80000000
    v_cmp_gt_u32 vcc, 34, v2
    s_nop 1
    v_cndmask_b32 v52, v59, v52, vcc
    v_cndmask_b32 v57, v59, v57, vcc
    buffer_load_dwordx4 v[60:63], v57, s[24:27], 0 offen
    s_mov_b32 s36, s34
    s_mov_b32 s37, s35
    s_mov_b32 s38, 0x510000
    s_mov_b32 s39, 0x00020000
    s_getpc_b64 s[56:57]
K0_PC571:
    v_lshrrev_b32 v72, 6, v0
    s_lshr_b32 s58, s2, 3
    s_lshl_b32 s58, s58, 2
    v_readfirstlane_b32 s59, v72
    s_add_u32 s58, s58, s59
    s_mul_i32 s58, s58, 320
    s_min_u32 s58, s58, K1_LAST-k1_kernel-320
    s_add_u32 s58, s58, k1_kernel-K0_PC571
    s_add_u32 s56, s56, s58
    s_addc_u32 s57, s57, 0
    s_load_dword s60, s[56:57], 0
    s_load_dword s60, s[56:57], 64
    s_load_dword s60, s[56:57], 128
    s_load_dword s60, s[56:57], 192
    s_load_dword s60, s[56:57], 256
    s_lshr_b32 s44, s2, 3
    s_mul_i32 s44, s44, 165888
    s_and_b32 s45, s2, 7
    s_mul_i32 s45, s45, 1152
    s_add_u32 s44, s44, s45
    v_add_u32 v72, 0, v0
    v_min_u32 v72, 323, v72
    v_mul_u32_u24 v73, 3641, v72
    v_lshrrev_b32 v73, 16, v73
    v_mul_u32_u24 v74, 18, v73
    v_sub_u32 v74, v72, v74
    v_mul_u32_u24 v73, 9216, v73
    v_lshl_add_u32 v73, v74, 6, v73
    buffer_load_dword v75, v73, s[36:39], s44 offen
    v_add_u32 v72, 256, v0
    v_min_u32 v72, 323, v72
    v_mul_u32_u24 v73, 3641, v72
    v_lshrrev_b32 v73, 16, v73
    v_mul_u32_u24 v74, 18, v73
    v_sub_u32 v74, v72, v74
    v_mul_u32_u24 v73, 9216, v73
    v_lshl_add_u32 v73, v74, 6, v73
    buffer_load_dword v75, v73, s[36:39], s44 offen
    s_waitcnt vmcnt(21)
    buffer_store_dword v10, v4, s[20:23], 0 offen offset:0
    s_mov_b32 s43, 512
    s_waitcnt vmcnt(21)
    buffer_store_dword v11, v4, s[20:23], s43 offen
    s_mov_b32 s43, 1024
    s_waitcnt vmcnt(21)
    buffer_store_dword v12, v4, s[20:23], s43 offen
    s_mov_b32 s43, 1536
    s_waitcnt vmcnt(21)
    buffer_store_dword v13, v4, s[20:23], s43 offen
    s_mov_b32 s43, 2048
    s_waitcnt vmcnt(21)
    buffer_store_dword v14, v4, s[20:23], s43 offen
    s_mov_b32 s43, 2560
    s_waitcnt vmcnt(21)
    buffer_store_dword v15, v4, s[20:23], s43 offen
    s_mov_b32 s43, 3072
    s_waitcnt vmcnt(21)
    buffer_store_dword v16, v4, s[20:23], s43 offen
    s_mov_b32 s43, 3584
    s_waitcnt vmcnt(21)
    buffer_store_dword v17, v4, s[20:23], s43 offen
    s_mov_b32 s43, 4096
    s_waitcnt vmcnt(21)
    buffer_store_dword v18, v4, s[20:23], s43 offen
    s_mov_b32 s43, 4608
    s_waitcnt vmcnt(21)
    buffer_store_dword v19, v4, s[20:23], s43 offen
    s_mov_b32 s43, 5120
    s_waitcnt vmcnt(21)
    buffer_store_dword v20, v4, s[20:23], s43 offen
    s_mov_b32 s43, 5632
    s_waitcnt vmcnt(21)
    buffer_store_dword v21, v4, s[20:23], s43 offen
    s_mov_b32 s43, 6144
    s_waitcnt vmcnt(21)
    buffer_store_dword v22, v4, s[20:23], s43 offen
    s_mov_b32 s43, 6656
    s_waitcnt vmcnt(21)
    buffer_store_dword v23, v4, s[20:23], s43 offen
    s_mov_b32 s43, 7168
    s_waitcnt vmcnt(21)
    buffer_store_dword v24, v4, s[20:23], s43 offen
    s_mov_b32 s43, 7680
    s_waitcnt vmcnt(21)
    buffer_store_dword v25, v4, s[20:23], s43 offen
    s_mov_b32 s43, 8192
    s_waitcnt vmcnt(21)
    buffer_store_dword v26, v4, s[20:23], s43 offen
    s_mov_b32 s43, 8704
    s_waitcnt vmcnt(21)
    buffer_store_dword v27, v4, s[20:23], s43 offen
    s_mov_b32 s43, 9216
    s_waitcnt vmcnt(20)
    buffer_store_dwordx4 v[48:51], v40, s[28:31], 0 offen
    buffer_store_dwordx4 v[60:63], v52, s[28:31], 0 offen
    s_cmp_ge_u32 s2, 24
    s_cbranch_scc1 K0_NOFLAG
    s_add_u32 s36, s54, 0x2b62000
    s_addc_u32 s37, s55, 0
    s_mov_b32 s38, 0xc000
    s_mov_b32 s39, 0x00020000
    v_mov_b32 v76, 0
    v_mov_b32 v77, 0
    v_mov_b32 v78, 0
    v_mov_b32 v79, 0
    v_lshlrev_b32 v72, 4, v2
    s_lshl_b32 s44, s2, 11
    buffer_store_dwordx4 v[76:79], v72, s[36:39], s44 offen
K0_NOFLAG:
K0_END:
    s_endpgm
.globl k1_kernel
.p2align 8
.type k1_kernel,@function
k1_kernel:
    s_cmp_ge_u32 s2, 256
    s_cbranch_scc1 K1_END
    s_load_dwordx4 s[56:59], s[0:1], 32
    s_load_dwordx2 s[54:55], s[0:1], 64
    s_load_dwordx2 s[60:61], s[0:1], 48
    s_load_dwordx2 s[52:53], s[0:1], 0
    v_and_b32 v226, 63, v0
    v_lshrrev_b32 v232, 6, v0
    v_lshrrev_b32 v227, 4, v226
    v_readfirstlane_b32 s28, v232
    v_and_b32 v228, 15, v226
    v_mov_b32 v229, v0
    s_and_b32 s40, s2, 7
    s_lshr_b32 s41, s2, 3
    s_lshr_b32 s30, s41, 2
    s_and_b32 s41, s41, 3
    s_lshl_b32 s40, s40, 2
    s_add_u32 s29, s40, s41
    s_mul_i32 s40, s28, 12
    s_mul_i32 s41, s29, 288
    s_and_b32 s42, s29, 1
    s_lshl_b32 s43, s42, 5
    s_add_u32 s43, s43, s41
    s_xor_b32 s42, s42, 1
    s_lshl_b32 s42, s42, 8
    s_add_u32 s42, s42, s41
    s_mov_b32 s41, 9216
    v_lshrrev_b32 v232, 4, v226
    v_add3_u32 v232, v232, s40, 0
    v_bfe_u32 v233, v226, 1, 3
    v_xor_b32 v233, v233, v232
    v_and_b32 v233, 7, v233
    v_mul_lo_u32 v232, v232, s41
    v_lshl_add_u32 v232, v233, 5, v232
    v_and_b32 v233, 1, v226
    v_lshl_add_u32 v232, v233, 4, v232
    v_add_u32 v217, s43, v232
    s_sub_u32 s43, s43, 1024
    v_lshrrev_b32 v232, 4, v226
    v_add3_u32 v232, v232, s40, 4
    v_bfe_u32 v233, v226, 1, 3
    v_xor_b32 v233, v233, v232
    v_and_b32 v233, 7, v233
    v_mul_lo_u32 v232, v232, s41
    v_lshl_add_u32 v232, v233, 5, v232
    v_and_b32 v233, 1, v226
    v_lshl_add_u32 v232, v233, 4, v232
    v_add_u32 v218, s43, v232
    s_sub_u32 s43, s43, 1024
    v_lshrrev_b32 v232, 4, v226
    v_add3_u32 v232, v232, s40, 8
    v_bfe_u32 v233, v226, 1, 3
    v_xor_b32 v233, v233, v232
    v_and_b32 v233, 7, v233
    v_mul_lo_u32 v232, v232, s41
    v_lshl_add_u32 v232, v233, 5, v232
    v_and_b32 v233, 1, v226
    v_lshl_add_u32 v232, v233, 4, v232
    v_add_u32 v219, s43, v232
    s_sub_u32 s43, s43, 1024
    v_lshrrev_b32 v232, 1, v226
    v_add_u32 v232, s40, v232
    v_mul_lo_u32 v232, v232, s41
    v_lshl_add_u32 v232, v233, 4, v232
    v_add_u32 v220, s42, v232
    s_mul_i32 s41, s29, 73728
    v_lshrrev_b32 v232, 3, v226
    v_add3_u32 v232, v232, s40, 0
    v_lshrrev_b32 v233, 1, v232
    v_bfe_u32 v234, v226, 1, 2
    v_xor_b32 v233, v233, v234
    v_and_b32 v233, 3, v233
    v_lshlrev_b32 v232, 7, v232
    v_lshl_add_u32 v232, v233, 5, v232
    v_and_b32 v233, 1, v226
    v_lshl_add_u32 v232, v233, 4, v232
    v_add_u32 v221, s41, v232
    s_sub_u32 s41, s41, 1024
    v_lshrrev_b32 v232, 3, v226
    v_add3_u32 v232, v232, s40, 8
    v_lshrrev_b32 v233, 1, v232
    v_bfe_u32 v234, v226, 1, 2
    v_xor_b32 v233, v233, v234
    v_and_b32 v233, 3, v233
    v_lshlrev_b32 v232, 7, v232
    v_lshl_add_u32 v232, v233, 5, v232
    v_and_b32 v233, 1, v226
    v_lshl_add_u32 v232, v233, 4, v232
    v_add_u32 v222, s41, v232
    s_sub_u32 s41, s41, 1024
    s_mul_i32 s39, s28, 3072
    s_mul_i32 s44, s28, 384
    s_add_u32 s44, s44, 24576
    s_mul_i32 s45, s28, 1536
    s_add_u32 s45, s45, 27648
    s_mov_b32 s37, 0
    s_mov_b32 s38, 0
    s_mov_b32 s36, 0
    s_waitcnt lgkmcnt(0)
    s_add_u32 s8, s54, 0x1440000
    s_addc_u32 s9, s55, 0
    s_mov_b32 s10, 0x240000
    s_mov_b32 s11, 0x00020000
    s_mov_b32 s12, s56
    s_mov_b32 s13, s57
    s_mov_b32 s14, 0x510000
    s_mov_b32 s15, 0x00020000
    s_mov_b32 s20, s54
    s_mov_b32 s21, s55
    s_mov_b32 s22, 0x1200000
    s_mov_b32 s23, 0x00020000
    s_add_u32 s24, s54, 0x1200000
    s_addc_u32 s25, s55, 0
    s_mov_b32 s26, 0x240000
    s_mov_b32 s27, 0x00020000
    s_add_u32 s16, s54, 0x1680000
    s_addc_u32 s17, s55, 0
    s_mov_b32 s18, 0x240000
    s_mov_b32 s19, 0x00020000
    s_add_u32 s40, s29, 1
    s_mul_i32 s18, s40, 73728
    s_cmp_lt_u32 s28, 4
    s_cbranch_scc1 K1_NP
    s_setprio 1
K1_NP:
    s_mov_b32 s34, 0
    s_mov_b32 s33, 0
    s_mov_b32 s32, 0
    s_add_u32 m0, s34, s39
    s_nop 0
    buffer_load_dwordx4 v217, s[12:15], s37 offen offset:0 lds
    s_add_u32 m0, s34, s39
    s_nop 0
    buffer_load_dwordx4 v218, s[12:15], s37 offen offset:1024 lds
    s_add_u32 m0, s34, s39
    s_nop 0
    buffer_load_dwordx4 v219, s[12:15], s37 offen offset:2048 lds
    s_add_u32 m0, s34, s44
    s_mov_b32 exec_lo, 0xffffff
    s_mov_b32 exec_hi, 0
    buffer_load_dwordx4 v220, s[12:15], s37 offen offset:0 lds
    s_mov_b64 exec, -1
    s_add_u32 m0, s34, s45
    s_nop 0
    buffer_load_dwordx4 v221, s[16:19], s38 offen offset:0 lds
    s_add_u32 m0, s34, s45
    s_mov_b32 exec_lo, 0xffffffff
    s_mov_b32 exec_hi, 0
    buffer_load_dwordx4 v222, s[16:19], s38 offen offset:1024 lds
    s_mov_b64 exec, -1
    s_add_u32 s37, s37, 884736
    s_add_u32 s38, s38, 12288
    s_add_u32 s34, s34, 39936
    s_cmp_ge_u32 s34, 159744
    s_cselect_b32 s34, 0, s34
    v_lshrrev_b32 v232, 2, v226
    v_and_b32 v233, 3, v226
    v_and_b32 v234, 7, v232
    v_lshlrev_b32 v235, 8, v232
    v_lshl_add_u32 v235, v234, 5, v235
    v_lshl_add_u32 v204, v233, 3, v235
    v_xor_b32 v205, 32, v204
    v_xor_b32 v206, 64, v204
    v_xor_b32 v207, 96, v204
    v_xor_b32 v208, 128, v204
    v_xor_b32 v209, 160, v204
    v_xor_b32 v210, 192, v204
    v_xor_b32 v211, 224, v204
    v_lshlrev_b32 v212, 3, v226
    v_add_u32 v212, 24576, v212
    v_lshrrev_b32 v232, 2, v226
    v_bfe_u32 v233, v226, 3, 2
    v_lshlrev_b32 v232, 7, v232
    v_lshl_add_u32 v232, v233, 5, v232
    v_and_b32 v233, 3, v226
    v_lshl_add_u32 v232, v233, 3, v232
    v_xor_b32 v213, 0, v232
    v_add_u32 v213, 27648, v213
    v_xor_b32 v214, 32, v232
    v_add_u32 v214, 27648, v214
    v_xor_b32 v215, 64, v232
    v_add_u32 v215, 27648, v215
    v_xor_b32 v216, 96, v232
    v_add_u32 v216, 27648, v216
    s_lshl_b32 s40, s30, 4
    s_lshl_b32 s41, s28, 1
    s_add_u32 s41, s41, s40
    s_lshl_b32 s41, s41, 10
    v_lshlrev_b32 v232, 4, v226
    v_add_u32 v223, s41, v232
    s_sub_u32 s41, s40, 1
    s_lshl_b32 s41, s41, 10
    s_cmp_eq_u32 s30, 0
    s_cselect_b32 s41, 0x80000000, s41
    s_cmp_gt_u32 s28, 2
    s_cselect_b32 s41, 0x80000000, s41
    v_add_u32 v225, s41, v232
    buffer_load_dwordx4 v[108:111], v223, s[8:11], s36 offen offset:0
    buffer_load_dwordx4 v[112:115], v223, s[8:11], s36 offen offset:1024
    buffer_load_dwordx4 v[116:119], v225, s[8:11], s36 offen offset:0
    s_add_u32 s36, s36, 0x20000
    buffer_load_dwordx4 v[120:123], v223, s[8:11], s36 offen offset:0
    buffer_load_dwordx4 v[124:127], v223, s[8:11], s36 offen offset:1024
    buffer_load_dwordx4 v[128:131], v225, s[8:11], s36 offen offset:0
    s_add_u32 s36, s36, 0x20000
    v_mov_b32 v0, 0
    v_mov_b32 v1, 0
    v_mov_b32 v2, 0
    v_mov_b32 v3, 0
    v_mov_b32 v4, 0
    v_mov_b32 v5, 0
    v_mov_b32 v6, 0
    v_mov_b32 v7, 0
    v_mov_b32 v8, 0
    v_mov_b32 v9, 0
    v_mov_b32 v10, 0
    v_mov_b32 v11, 0
    v_mov_b32 v12, 0
    v_mov_b32 v13, 0
    v_mov_b32 v14, 0
    v_mov_b32 v15, 0
    v_mov_b32 v16, 0
    v_mov_b32 v17, 0
    v_mov_b32 v18, 0
    v_mov_b32 v19, 0
    v_mov_b32 v20, 0
    v_mov_b32 v21, 0
    v_mov_b32 v22, 0
    v_mov_b32 v23, 0
    v_mov_b32 v24, 0
    v_mov_b32 v25, 0
    v_mov_b32 v26, 0
    v_mov_b32 v27, 0
    v_mov_b32 v28, 0
    v_mov_b32 v29, 0
    v_mov_b32 v30, 0
    v_mov_b32 v31, 0
    v_mov_b32 v32, 0
    v_mov_b32 v33, 0
    v_mov_b32 v34, 0
    v_mov_b32 v35, 0
    v_mov_b32 v36, 0
    v_mov_b32 v37, 0
    v_mov_b32 v38, 0
    v_mov_b32 v39, 0
    v_mov_b32 v40, 0
    v_mov_b32 v41, 0
    v_mov_b32 v42, 0
    v_mov_b32 v43, 0
    v_mov_b32 v44, 0
    v_mov_b32 v45, 0
    v_mov_b32 v46, 0
    v_mov_b32 v47, 0
    v_mov_b32 v48, 0
    v_mov_b32 v49, 0
    v_mov_b32 v50, 0
    v_mov_b32 v51, 0
    v_mov_b32 v52, 0
    v_mov_b32 v53, 0
    v_mov_b32 v54, 0
    v_mov_b32 v55, 0
    v_mov_b32 v56, 0
    v_mov_b32 v57, 0
    v_mov_b32 v58, 0
    v_mov_b32 v59, 0
    v_mov_b32 v60, 0
    v_mov_b32 v61, 0
    v_mov_b32 v62, 0
    v_mov_b32 v63, 0
    v_mov_b32 v64, 0
    v_mov_b32 v65, 0
    v_mov_b32 v66, 0
    v_mov_b32 v67, 0
    v_mov_b32 v68, 0
    v_mov_b32 v69, 0
    v_mov_b32 v70, 0
    v_mov_b32 v71, 0
    v_mov_b32 v72, 0
    v_mov_b32 v73, 0
    v_mov_b32 v74, 0
    v_mov_b32 v75, 0
    v_mov_b32 v76, 0
    v_mov_b32 v77, 0
    v_mov_b32 v78, 0
    v_mov_b32 v79, 0
    v_mov_b32 v80, 0
    v_mov_b32 v81, 0
    v_mov_b32 v82, 0
    v_mov_b32 v83, 0
    v_mov_b32 v84, 0
    v_mov_b32 v85, 0
    v_mov_b32 v86, 0
    v_mov_b32 v87, 0
    v_mov_b32 v88, 0
    v_mov_b32 v89, 0
    v_mov_b32 v90, 0
    v_mov_b32 v91, 0
    v_mov_b32 v92, 0
    v_mov_b32 v93, 0
    v_mov_b32 v94, 0
    v_mov_b32 v95, 0
    v_mov_b32 v96, 0
    v_mov_b32 v97, 0
    v_mov_b32 v98, 0
    v_mov_b32 v99, 0
    v_mov_b32 v100, 0
    v_mov_b32 v101, 0
    v_mov_b32 v102, 0
    v_mov_b32 v103, 0
    v_mov_b32 v104, 0
    v_mov_b32 v105, 0
    v_mov_b32 v106, 0
    v_mov_b32 v107, 0
    s_waitcnt vmcnt(6)
    s_barrier
    v_add_u32 v204, s32, v204
    ds_read_b64_tr_b16 v[180:181], v204 offset:0
    ds_read_b64_tr_b16 v[182:183], v204 offset:4096
    v_add_u32 v205, s32, v205
    ds_read_b64_tr_b16 v[184:185], v205 offset:0
    ds_read_b64_tr_b16 v[186:187], v205 offset:4096
    v_add_u32 v206, s32, v206
    ds_read_b64_tr_b16 v[188:189], v206 offset:0
    ds_read_b64_tr_b16 v[190:191], v206 offset:4096
    v_add_u32 v207, s32, v207
    ds_read_b64_tr_b16 v[192:193], v207 offset:0
    ds_read_b64_tr_b16 v[194:195], v207 offset:4096
    v_add_u32 v208, s32, v208
    ds_read_b64_tr_b16 v[196:197], v208 offset:0
    ds_read_b64_tr_b16 v[198:199], v208 offset:4096
    s_waitcnt vmcnt(3)
    s_waitcnt lgkmcnt(8)
    v_add_u32 v209, s32, v209
    ds_read_b64_tr_b16 v[200:201], v209 offset:0
    ds_read_b64_tr_b16 v[202:203], v209 offset:4096
    v_mfma_f32_16x16x32_bf16 v[0:3], v[180:183], v[108:111], v[0:3]
    v_mfma_f32_16x16x32_bf16 v[4:7], v[180:183], v[112:115], v[4:7]
    buffer_load_dwordx4 v[132:135], v223, s[8:11], s36 offen offset:0
    s_waitcnt lgkmcnt(8)
    v_add_u32 v210, s32, v210
    ds_read_b64_tr_b16 v[180:181], v210 offset:0
    ds_read_b64_tr_b16 v[182:183], v210 offset:4096
    v_mfma_f32_16x16x32_bf16 v[8:11], v[184:187], v[108:111], v[8:11]
    v_mfma_f32_16x16x32_bf16 v[12:15], v[184:187], v[112:115], v[12:15]
    buffer_load_dwordx4 v[136:139], v223, s[8:11], s36 offen offset:1024
    s_waitcnt lgkmcnt(8)
    v_add_u32 v211, s32, v211
    ds_read_b64_tr_b16 v[184:185], v211 offset:0
    ds_read_b64_tr_b16 v[186:187], v211 offset:4096
    v_mfma_f32_16x16x32_bf16 v[16:19], v[188:191], v[108:111], v[16:19]
    v_mfma_f32_16x16x32_bf16 v[20:23], v[188:191], v[112:115], v[20:23]
    buffer_load_dwordx4 v[140:143], v225, s[8:11], s36 offen offset:0
    s_add_u32 s36, s36, 0x20000
    s_waitcnt lgkmcnt(8)
    v_add_u32 v212, s32, v212
    ds_read_b64_tr_b16 v[188:189], v212 offset:0
    ds_read_b64_tr_b16 v[190:191], v212 offset:512
    v_mfma_f32_16x16x32_bf16 v[24:27], v[192:195], v[108:111], v[24:27]
    v_mfma_f32_16x16x32_bf16 v[28:31], v[192:195], v[112:115], v[28:31]
    s_add_u32 m0, s34, s39
    s_nop 0
    buffer_load_dwordx4 v217, s[12:15], s37 offen offset:0 lds
    s_waitcnt lgkmcnt(8)
    v_add_u32 v213, s32, v213
    ds_read_b64_tr_b16 v[192:193], v213 offset:0
    ds_read_b64_tr_b16 v[194:195], v213 offset:2048
    v_mfma_f32_16x16x32_bf16 v[32:35], v[196:199], v[108:111], v[32:35]
    v_mfma_f32_16x16x32_bf16 v[36:39], v[196:199], v[112:115], v[36:39]
    s_add_u32 m0, s34, s39
    s_nop 0
    buffer_load_dwordx4 v218, s[12:15], s37 offen offset:1024 lds
    s_waitcnt lgkmcnt(8)
    v_add_u32 v214, s32, v214
    ds_read_b64_tr_b16 v[196:197], v214 offset:0
    ds_read_b64_tr_b16 v[198:199], v214 offset:2048
    v_mfma_f32_16x16x32_bf16 v[40:43], v[200:203], v[108:111], v[40:43]
    v_mfma_f32_16x16x32_bf16 v[44:47], v[200:203], v[112:115], v[44:47]
    s_add_u32 m0, s34, s39
    s_nop 0
    buffer_load_dwordx4 v219, s[12:15], s37 offen offset:2048 lds
    s_waitcnt lgkmcnt(8)
    v_add_u32 v215, s32, v215
    ds_read_b64_tr_b16 v[200:201], v215 offset:0
    ds_read_b64_tr_b16 v[202:203], v215 offset:2048
    v_mfma_f32_16x16x32_bf16 v[48:51], v[180:183], v[108:111], v[48:51]
    v_mfma_f32_16x16x32_bf16 v[52:55], v[180:183], v[112:115], v[52:55]
    s_add_u32 m0, s34, s44
    s_mov_b32 exec_lo, 0xffffff
    s_mov_b32 exec_hi, 0
    buffer_load_dwordx4 v220, s[12:15], s37 offen offset:0 lds
    s_mov_b64 exec, -1
    s_waitcnt lgkmcnt(8)
    v_add_u32 v216, s32, v216
    ds_read_b64_tr_b16 v[180:181], v216 offset:0
    ds_read_b64_tr_b16 v[182:183], v216 offset:2048
    v_mfma_f32_16x16x32_bf16 v[56:59], v[184:187], v[108:111], v[56:59]
    v_mfma_f32_16x16x32_bf16 v[60:63], v[184:187], v[112:115], v[60:63]
    s_add_u32 m0, s34, s45
    s_nop 0
    buffer_load_dwordx4 v221, s[16:19], s38 offen offset:0 lds
    s_waitcnt lgkmcnt(8)
    ds_read_b64_tr_b16 v[184:185], v204 offset:8192
    ds_read_b64_tr_b16 v[186:187], v204 offset:12288
    v_mfma_f32_16x16x32_bf16 v[64:67], v[188:191], v[108:111], v[64:67]
    v_mfma_f32_16x16x32_bf16 v[68:71], v[188:191], v[112:115], v[68:71]
    s_add_u32 m0, s34, s45
    s_mov_b32 exec_lo, 0xffffffff
    s_mov_b32 exec_hi, 0
    buffer_load_dwordx4 v222, s[16:19], s38 offen offset:1024 lds
    s_mov_b64 exec, -1
    s_add_u32 s37, s37, 884736
    s_add_u32 s38, s38, 12288
    s_add_u32 s34, s34, 39936
    s_cmp_ge_u32 s34, 159744
    s_cselect_b32 s34, 0, s34
    s_waitcnt lgkmcnt(8)
    ds_read_b64_tr_b16 v[188:189], v205 offset:8192
    ds_read_b64_tr_b16 v[190:191], v205 offset:12288
    v_mfma_f32_16x16x32_bf16 v[72:75], v[192:195], v[108:111], v[72:75]
    v_mfma_f32_16x16x32_bf16 v[76:79], v[192:195], v[112:115], v[76:79]
    buffer_load_dwordx4 v[144:147], v223, s[8:11], s36 offen offset:0
    s_waitcnt lgkmcnt(8)
    ds_read_b64_tr_b16 v[192:193], v206 offset:8192
    ds_read_b64_tr_b16 v[194:195], v206 offset:12288
    v_mfma_f32_16x16x32_bf16 v[80:83], v[196:199], v[108:111], v[80:83]
    v_mfma_f32_16x16x32_bf16 v[84:87], v[196:199], v[112:115], v[84:87]
    s_cmp_eq_u32 s28, 0
    s_cbranch_scc0 K1_XP10_0
    v_mfma_f32_16x16x32_bf16 v[104:107], v[196:199], v[116:119], v[104:107]
K1_XP10_0:
    buffer_load_dwordx4 v[148:151], v223, s[8:11], s36 offen offset:1024
    s_waitcnt lgkmcnt(8)
    ds_read_b64_tr_b16 v[196:197], v207 offset:8192
    ds_read_b64_tr_b16 v[198:199], v207 offset:12288
    v_mfma_f32_16x16x32_bf16 v[88:91], v[200:203], v[108:111], v[88:91]
    v_mfma_f32_16x16x32_bf16 v[92:95], v[200:203], v[112:115], v[92:95]
    s_cmp_eq_u32 s28, 1
    s_cbranch_scc0 K1_XP11_0
    v_mfma_f32_16x16x32_bf16 v[104:107], v[200:203], v[116:119], v[104:107]
K1_XP11_0:
    buffer_load_dwordx4 v[152:155], v225, s[8:11], s36 offen offset:0
    s_add_u32 s36, s36, 0x20000
    s_waitcnt lgkmcnt(8)
    ds_read_b64_tr_b16 v[200:201], v208 offset:8192
    ds_read_b64_tr_b16 v[202:203], v208 offset:12288
    v_mfma_f32_16x16x32_bf16 v[96:99], v[180:183], v[108:111], v[96:99]
    v_mfma_f32_16x16x32_bf16 v[100:103], v[180:183], v[112:115], v[100:103]
    s_cmp_eq_u32 s28, 2
    s_cbranch_scc0 K1_XP12_0
    v_mfma_f32_16x16x32_bf16 v[104:107], v[180:183], v[116:119], v[104:107]
K1_XP12_0:
    s_waitcnt vmcnt(12)
    s_waitcnt lgkmcnt(8)
    ds_read_b64_tr_b16 v[180:181], v209 offset:8192
    ds_read_b64_tr_b16 v[182:183], v209 offset:12288
    v_mfma_f32_16x16x32_bf16 v[0:3], v[184:187], v[120:123], v[0:3]
    v_mfma_f32_16x16x32_bf16 v[4:7], v[184:187], v[124:127], v[4:7]
    buffer_load_dwordx4 v[156:159], v223, s[8:11], s36 offen offset:0
    s_waitcnt lgkmcnt(8)
    ds_read_b64_tr_b16 v[184:185], v210 offset:8192
    ds_read_b64_tr_b16 v[186:187], v210 offset:12288
    v_mfma_f32_16x16x32_bf16 v[8:11], v[188:191], v[120:123], v[8:11]
    v_mfma_f32_16x16x32_bf16 v[12:15], v[188:191], v[124:127], v[12:15]
    buffer_load_dwordx4 v[160:163], v223, s[8:11], s36 offen offset:1024
    s_waitcnt lgkmcnt(8)
    ds_read_b64_tr_b16 v[188:189], v211 offset:8192
    ds_read_b64_tr_b16 v[190:191], v211 offset:12288
    v_mfma_f32_16x16x32_bf16 v[16:19], v[192:195], v[120:123], v[16:19]
    v_mfma_f32_16x16x32_bf16 v[20:23], v[192:195], v[124:127], v[20:23]
    buffer_load_dwordx4 v[164:167], v225, s[8:11], s36 offen offset:0
    s_add_u32 s36, s36, 0x20000
    s_waitcnt lgkmcnt(8)
    ds_read_b64_tr_b16 v[192:193], v212 offset:1024
    ds_read_b64_tr_b16 v[194:195], v212 offset:1536
    v_mfma_f32_16x16x32_bf16 v[24:27], v[196:199], v[120:123], v[24:27]
    v_mfma_f32_16x16x32_bf16 v[28:31], v[196:199], v[124:127], v[28:31]
    s_add_u32 m0, s34, s39
    s_nop 0
    buffer_load_dwordx4 v217, s[12:15], s37 offen offset:0 lds
    s_waitcnt lgkmcnt(8)
    ds_read_b64_tr_b16 v[196:197], v213 offset:4096
    ds_read_b64_tr_b16 v[198:199], v213 offset:6144
    v_mfma_f32_16x16x32_bf16 v[32:35], v[200:203], v[120:123], v[32:35]
    v_mfma_f32_16x16x32_bf16 v[36:39], v[200:203], v[124:127], v[36:39]
    s_add_u32 m0, s34, s39
    s_nop 0
    buffer_load_dwordx4 v218, s[12:15], s37 offen offset:1024 lds
    s_waitcnt lgkmcnt(8)
    ds_read_b64_tr_b16 v[200:201], v214 offset:4096
    ds_read_b64_tr_b16 v[202:203], v214 offset:6144
    v_mfma_f32_16x16x32_bf16 v[40:43], v[180:183], v[120:123], v[40:43]
    v_mfma_f32_16x16x32_bf16 v[44:47], v[180:183], v[124:127], v[44:47]
    s_add_u32 m0, s34, s39
    s_nop 0
    buffer_load_dwordx4 v219, s[12:15], s37 offen offset:2048 lds
    s_waitcnt lgkmcnt(8)
    ds_read_b64_tr_b16 v[180:181], v215 offset:4096
    ds_read_b64_tr_b16 v[182:183], v215 offset:6144
    v_mfma_f32_16x16x32_bf16 v[48:51], v[184:187], v[120:123], v[48:51]
    v_mfma_f32_16x16x32_bf16 v[52:55], v[184:187], v[124:127], v[52:55]
    s_add_u32 m0, s34, s44
    s_mov_b32 exec_lo, 0xffffff
    s_mov_b32 exec_hi, 0
    buffer_load_dwordx4 v220, s[12:15], s37 offen offset:0 lds
    s_mov_b64 exec, -1
    s_waitcnt lgkmcnt(8)
    ds_read_b64_tr_b16 v[184:185], v216 offset:4096
    ds_read_b64_tr_b16 v[186:187], v216 offset:6144
    v_mfma_f32_16x16x32_bf16 v[56:59], v[188:191], v[120:123], v[56:59]
    v_mfma_f32_16x16x32_bf16 v[60:63], v[188:191], v[124:127], v[60:63]
    s_add_u32 m0, s34, s45
    s_nop 0
    buffer_load_dwordx4 v221, s[16:19], s38 offen offset:0 lds
    s_waitcnt lgkmcnt(8)
    ds_read_b64_tr_b16 v[188:189], v204 offset:16384
    ds_read_b64_tr_b16 v[190:191], v204 offset:20480
    v_mfma_f32_16x16x32_bf16 v[64:67], v[192:195], v[120:123], v[64:67]
    v_mfma_f32_16x16x32_bf16 v[68:71], v[192:195], v[124:127], v[68:71]
    s_add_u32 m0, s34, s45
    s_mov_b32 exec_lo, 0xffffffff
    s_mov_b32 exec_hi, 0
    buffer_load_dwordx4 v222, s[16:19], s38 offen offset:1024 lds
    s_mov_b64 exec, -1
    s_add_u32 s37, s37, 884736
    s_add_u32 s38, s38, 12288
    s_add_u32 s34, s34, 39936
    s_cmp_ge_u32 s34, 159744
    s_cselect_b32 s34, 0, s34
    s_waitcnt lgkmcnt(8)
    ds_read_b64_tr_b16 v[192:193], v205 offset:16384
    ds_read_b64_tr_b16 v[194:195], v205 offset:20480
    v_mfma_f32_16x16x32_bf16 v[72:75], v[196:199], v[120:123], v[72:75]
    v_mfma_f32_16x16x32_bf16 v[76:79], v[196:199], v[124:127], v[76:79]
    buffer_load_dwordx4 v[168:171], v223, s[8:11], s36 offen offset:0
    s_waitcnt lgkmcnt(8)
    ds_read_b64_tr_b16 v[196:197], v206 offset:16384
    ds_read_b64_tr_b16 v[198:199], v206 offset:20480
    v_mfma_f32_16x16x32_bf16 v[80:83], v[200:203], v[120:123], v[80:83]
    v_mfma_f32_16x16x32_bf16 v[84:87], v[200:203], v[124:127], v[84:87]
    s_cmp_eq_u32 s28, 0
    s_cbranch_scc0 K1_XP10_1
    v_mfma_f32_16x16x32_bf16 v[104:107], v[200:203], v[128:131], v[104:107]
K1_XP10_1:
    buffer_load_dwordx4 v[172:175], v223, s[8:11], s36 offen offset:1024
    s_waitcnt lgkmcnt(8)
    ds_read_b64_tr_b16 v[200:201], v207 offset:16384
    ds_read_b64_tr_b16 v[202:203], v207 offset:20480
    v_mfma_f32_16x16x32_bf16 v[88:91], v[180:183], v[120:123], v[88:91]
    v_mfma_f32_16x16x32_bf16 v[92:95], v[180:183], v[124:127], v[92:95]
    s_cmp_eq_u32 s28, 1
    s_cbranch_scc0 K1_XP11_1
    v_mfma_f32_16x16x32_bf16 v[104:107], v[180:183], v[128:131], v[104:107]
K1_XP11_1:
    buffer_load_dwordx4 v[176:179], v225, s[8:11], s36 offen offset:0
    s_add_u32 s36, s36, 0x20000
    s_waitcnt lgkmcnt(8)
    ds_read_b64_tr_b16 v[180:181], v208 offset:16384
    ds_read_b64_tr_b16 v[182:183], v208 offset:20480
    v_mfma_f32_16x16x32_bf16 v[96:99], v[184:187], v[120:123], v[96:99]
    v_mfma_f32_16x16x32_bf16 v[100:103], v[184:187], v[124:127], v[100:103]
    s_cmp_eq_u32 s28, 2
    s_cbranch_scc0 K1_XP12_1
    v_mfma_f32_16x16x32_bf16 v[104:107], v[184:187], v[128:131], v[104:107]
K1_XP12_1:
    s_waitcnt vmcnt(15)
    s_add_u32 s33, s33, 39936
    s_cmp_ge_u32 s33, 159744
    s_cselect_b32 s32, 159744, 0
    s_sub_u32 s33, s33, s32
    s_sub_u32 s32, 39936, s32
    s_waitcnt lgkmcnt(8)
    ds_read_b64_tr_b16 v[184:185], v209 offset:16384
    ds_read_b64_tr_b16 v[186:187], v209 offset:20480
    v_mfma_f32_16x16x32_bf16 v[0:3], v[188:191], v[132:135], v[0:3]
    v_mfma_f32_16x16x32_bf16 v[4:7], v[188:191], v[136:139], v[4:7]
    buffer_load_dwordx4 v[108:111], v223, s[8:11], s36 offen offset:0
    s_waitcnt lgkmcnt(8)
    ds_read_b64_tr_b16 v[188:189], v210 offset:16384
    ds_read_b64_tr_b16 v[190:191], v210 offset:20480
    v_mfma_f32_16x16x32_bf16 v[8:11], v[192:195], v[132:135], v[8:11]
    v_mfma_f32_16x16x32_bf16 v[12:15], v[192:195], v[136:139], v[12:15]
    buffer_load_dwordx4 v[112:115], v223, s[8:11], s36 offen offset:1024
    s_waitcnt lgkmcnt(8)
    ds_read_b64_tr_b16 v[192:193], v211 offset:16384
    ds_read_b64_tr_b16 v[194:195], v211 offset:20480
    v_mfma_f32_16x16x32_bf16 v[16:19], v[196:199], v[132:135], v[16:19]
    v_mfma_f32_16x16x32_bf16 v[20:23], v[196:199], v[136:139], v[20:23]
    buffer_load_dwordx4 v[116:119], v225, s[8:11], s36 offen offset:0
    s_add_u32 s36, s36, 0x20000
    s_waitcnt lgkmcnt(8)
    ds_read_b64_tr_b16 v[196:197], v212 offset:2048
    ds_read_b64_tr_b16 v[198:199], v212 offset:2560
    v_mfma_f32_16x16x32_bf16 v[24:27], v[200:203], v[132:135], v[24:27]
    v_mfma_f32_16x16x32_bf16 v[28:31], v[200:203], v[136:139], v[28:31]
    buffer_load_dwordx4 v[120:123], v223, s[8:11], s36 offen offset:0
    s_waitcnt lgkmcnt(8)
    ds_read_b64_tr_b16 v[200:201], v213 offset:8192
    ds_read_b64_tr_b16 v[202:203], v213 offset:10240
    v_mfma_f32_16x16x32_bf16 v[32:35], v[180:183], v[132:135], v[32:35]
    v_mfma_f32_16x16x32_bf16 v[36:39], v[180:183], v[136:139], v[36:39]
    buffer_load_dwordx4 v[124:127], v223, s[8:11], s36 offen offset:1024
    s_waitcnt lgkmcnt(8)
    ds_read_b64_tr_b16 v[180:181], v214 offset:8192
    ds_read_b64_tr_b16 v[182:183], v214 offset:10240
    v_mfma_f32_16x16x32_bf16 v[40:43], v[184:187], v[132:135], v[40:43]
    v_mfma_f32_16x16x32_bf16 v[44:47], v[184:187], v[136:139], v[44:47]
    buffer_load_dwordx4 v[128:131], v225, s[8:11], s36 offen offset:0
    s_add_u32 s36, s36, 0x20000
    s_waitcnt lgkmcnt(8)
    ds_read_b64_tr_b16 v[184:185], v215 offset:8192
    ds_read_b64_tr_b16 v[186:187], v215 offset:10240
    v_mfma_f32_16x16x32_bf16 v[48:51], v[188:191], v[132:135], v[48:51]
    v_mfma_f32_16x16x32_bf16 v[52:55], v[188:191], v[136:139], v[52:55]
    s_add_u32 m0, s34, s39
    s_nop 0
    buffer_load_dwordx4 v217, s[12:15], s37 offen offset:0 lds
    s_waitcnt lgkmcnt(8)
    ds_read_b64_tr_b16 v[188:189], v216 offset:8192
    ds_read_b64_tr_b16 v[190:191], v216 offset:10240
    v_mfma_f32_16x16x32_bf16 v[56:59], v[192:195], v[132:135], v[56:59]
    v_mfma_f32_16x16x32_bf16 v[60:63], v[192:195], v[136:139], v[60:63]
    s_add_u32 m0, s34, s39
    s_nop 0
    buffer_load_dwordx4 v218, s[12:15], s37 offen offset:1024 lds
    s_waitcnt lgkmcnt(8)
    s_barrier
    v_add_u32 v204, s32, v204
    ds_read_b64_tr_b16 v[192:193], v204 offset:0
    ds_read_b64_tr_b16 v[194:195], v204 offset:4096
    v_mfma_f32_16x16x32_bf16 v[64:67], v[196:199], v[132:135], v[64:67]
    v_mfma_f32_16x16x32_bf16 v[68:71], v[196:199], v[136:139], v[68:71]
    s_add_u32 m0, s34, s39
    s_nop 0
    buffer_load_dwordx4 v219, s[12:15], s37 offen offset:2048 lds
    s_waitcnt lgkmcnt(8)
    v_add_u32 v205, s32, v205
    ds_read_b64_tr_b16 v[196:197], v205 offset:0
    ds_read_b64_tr_b16 v[198:199], v205 offset:4096
    v_mfma_f32_16x16x32_bf16 v[72:75], v[200:203], v[132:135], v[72:75]
    v_mfma_f32_16x16x32_bf16 v[76:79], v[200:203], v[136:139], v[76:79]
    s_add_u32 m0, s34, s44
    s_mov_b32 exec_lo, 0xffffff
    s_mov_b32 exec_hi, 0
    buffer_load_dwordx4 v220, s[12:15], s37 offen offset:0 lds
    s_mov_b64 exec, -1
    s_waitcnt lgkmcnt(8)
    v_add_u32 v206, s32, v206
    ds_read_b64_tr_b16 v[200:201], v206 offset:0
    ds_read_b64_tr_b16 v[202:203], v206 offset:4096
    v_mfma_f32_16x16x32_bf16 v[80:83], v[180:183], v[132:135], v[80:83]
    v_mfma_f32_16x16x32_bf16 v[84:87], v[180:183], v[136:139], v[84:87]
    s_cmp_eq_u32 s28, 0
    s_cbranch_scc0 K1_XP10_2
    v_mfma_f32_16x16x32_bf16 v[104:107], v[180:183], v[140:143], v[104:107]
K1_XP10_2:
    s_add_u32 m0, s34, s45
    s_nop 0
    buffer_load_dwordx4 v221, s[16:19], s38 offen offset:0 lds
    s_waitcnt lgkmcnt(8)
    v_add_u32 v207, s32, v207
    ds_read_b64_tr_b16 v[180:181], v207 offset:0
    ds_read_b64_tr_b16 v[182:183], v207 offset:4096
    v_mfma_f32_16x16x32_bf16 v[88:91], v[184:187], v[132:135], v[88:91]
    v_mfma_f32_16x16x32_bf16 v[92:95], v[184:187], v[136:139], v[92:95]
    s_cmp_eq_u32 s28, 1
    s_cbranch_scc0 K1_XP11_2
    v_mfma_f32_16x16x32_bf16 v[104:107], v[184:187], v[140:143], v[104:107]
K1_XP11_2:
    s_add_u32 m0, s34, s45
    s_mov_b32 exec_lo, 0xffffffff
    s_mov_b32 exec_hi, 0
    buffer_load_dwordx4 v222, s[16:19], s38 offen offset:1024 lds
    s_mov_b64 exec, -1
    s_add_u32 s37, s37, 884736
    s_add_u32 s38, s38, 12288
    s_add_u32 s34, s34, 39936
    s_cmp_ge_u32 s34, 159744
    s_cselect_b32 s34, 0, s34
    s_waitcnt lgkmcnt(8)
    v_add_u32 v208, s32, v208
    ds_read_b64_tr_b16 v[184:185], v208 offset:0
    ds_read_b64_tr_b16 v[186:187], v208 offset:4096
    v_mfma_f32_16x16x32_bf16 v[96:99], v[188:191], v[132:135], v[96:99]
    v_mfma_f32_16x16x32_bf16 v[100:103], v[188:191], v[136:139], v[100:103]
    s_cmp_eq_u32 s28, 2
    s_cbranch_scc0 K1_XP12_2
    v_mfma_f32_16x16x32_bf16 v[104:107], v[188:191], v[140:143], v[104:107]
K1_XP12_2:
    s_mov_b32 s31, 3
    s_branch K1_MID
K1_LOOP:
    s_waitcnt vmcnt(22)
    s_waitcnt lgkmcnt(8)
    v_add_u32 v209, s32, v209
    ds_read_b64_tr_b16 v[200:201], v209 offset:0
    ds_read_b64_tr_b16 v[202:203], v209 offset:4096
    v_mfma_f32_16x16x32_bf16 v[0:3], v[180:183], v[108:111], v[0:3]
    v_mfma_f32_16x16x32_bf16 v[4:7], v[180:183], v[112:115], v[4:7]
    buffer_load_dwordx4 v[168:171], v223, s[8:11], s36 offen offset:0
    s_waitcnt lgkmcnt(8)
    v_add_u32 v210, s32, v210
    ds_read_b64_tr_b16 v[180:181], v210 offset:0
    ds_read_b64_tr_b16 v[182:183], v210 offset:4096
    v_mfma_f32_16x16x32_bf16 v[8:11], v[184:187], v[108:111], v[8:11]
    v_mfma_f32_16x16x32_bf16 v[12:15], v[184:187], v[112:115], v[12:15]
    s_waitcnt lgkmcnt(8)
    v_add_u32 v211, s32, v211
    ds_read_b64_tr_b16 v[184:185], v211 offset:0
    ds_read_b64_tr_b16 v[186:187], v211 offset:4096
    v_mfma_f32_16x16x32_bf16 v[16:19], v[188:191], v[108:111], v[16:19]
    v_mfma_f32_16x16x32_bf16 v[20:23], v[188:191], v[112:115], v[20:23]
    buffer_load_dwordx4 v[172:175], v223, s[8:11], s36 offen offset:1024
    s_waitcnt lgkmcnt(8)
    v_add_u32 v212, s32, v212
    ds_read_b64_tr_b16 v[188:189], v212 offset:0
    ds_read_b64_tr_b16 v[190:191], v212 offset:512
    v_mfma_f32_16x16x32_bf16 v[24:27], v[192:195], v[108:111], v[24:27]
    v_mfma_f32_16x16x32_bf16 v[28:31], v[192:195], v[112:115], v[28:31]
    s_waitcnt lgkmcnt(8)
    v_add_u32 v213, s32, v213
    ds_read_b64_tr_b16 v[192:193], v213 offset:0
    ds_read_b64_tr_b16 v[194:195], v213 offset:2048
    v_mfma_f32_16x16x32_bf16 v[32:35], v[196:199], v[108:111], v[32:35]
    v_mfma_f32_16x16x32_bf16 v[36:39], v[196:199], v[112:115], v[36:39]
    buffer_load_dwordx4 v[176:179], v225, s[8:11], s36 offen offset:0
    s_add_u32 s36, s36, 0x20000
    s_waitcnt lgkmcnt(8)
    v_add_u32 v214, s32, v214
    ds_read_b64_tr_b16 v[196:197], v214 offset:0
    ds_read_b64_tr_b16 v[198:199], v214 offset:2048
    v_mfma_f32_16x16x32_bf16 v[40:43], v[200:203], v[108:111], v[40:43]
    v_mfma_f32_16x16x32_bf16 v[44:47], v[200:203], v[112:115], v[44:47]
    s_waitcnt lgkmcnt(8)
    v_add_u32 v215, s32, v215
    ds_read_b64_tr_b16 v[200:201], v215 offset:0
    ds_read_b64_tr_b16 v[202:203], v215 offset:2048
    v_mfma_f32_16x16x32_bf16 v[48:51], v[180:183], v[108:111], v[48:51]
    v_mfma_f32_16x16x32_bf16 v[52:55], v[180:183], v[112:115], v[52:55]
    s_waitcnt lgkmcnt(8)
    v_add_u32 v216, s32, v216
    ds_read_b64_tr_b16 v[180:181], v216 offset:0
    ds_read_b64_tr_b16 v[182:183], v216 offset:2048
    v_mfma_f32_16x16x32_bf16 v[56:59], v[184:187], v[108:111], v[56:59]
    v_mfma_f32_16x16x32_bf16 v[60:63], v[184:187], v[112:115], v[60:63]
    s_add_u32 m0, s34, s39
    s_nop 0
    buffer_load_dwordx4 v217, s[12:15], s37 offen offset:0 lds
    s_waitcnt lgkmcnt(8)
    ds_read_b64_tr_b16 v[184:185], v204 offset:8192
    ds_read_b64_tr_b16 v[186:187], v204 offset:12288
    v_mfma_f32_16x16x32_bf16 v[64:67], v[188:191], v[108:111], v[64:67]
    v_mfma_f32_16x16x32_bf16 v[68:71], v[188:191], v[112:115], v[68:71]
    s_waitcnt lgkmcnt(8)
    ds_read_b64_tr_b16 v[188:189], v205 offset:8192
    ds_read_b64_tr_b16 v[190:191], v205 offset:12288
    v_mfma_f32_16x16x32_bf16 v[72:75], v[192:195], v[108:111], v[72:75]
    v_mfma_f32_16x16x32_bf16 v[76:79], v[192:195], v[112:115], v[76:79]
    s_waitcnt lgkmcnt(8)
    ds_read_b64_tr_b16 v[192:193], v206 offset:8192
    ds_read_b64_tr_b16 v[194:195], v206 offset:12288
    v_mfma_f32_16x16x32_bf16 v[80:83], v[196:199], v[108:111], v[80:83]
    v_mfma_f32_16x16x32_bf16 v[84:87], v[196:199], v[112:115], v[84:87]
    s_cmp_eq_u32 s28, 0
    s_cbranch_scc0 K1_XL10_0
    v_mfma_f32_16x16x32_bf16 v[104:107], v[196:199], v[116:119], v[104:107]
K1_XL10_0:
    s_add_u32 m0, s34, s39
    s_nop 0
    buffer_load_dwordx4 v218, s[12:15], s37 offen offset:1024 lds
    s_waitcnt lgkmcnt(8)
    ds_read_b64_tr_b16 v[196:197], v207 offset:8192
    ds_read_b64_tr_b16 v[198:199], v207 offset:12288
    v_mfma_f32_16x16x32_bf16 v[88:91], v[200:203], v[108:111], v[88:91]
    v_mfma_f32_16x16x32_bf16 v[92:95], v[200:203], v[112:115], v[92:95]
    s_cmp_eq_u32 s28, 1
    s_cbranch_scc0 K1_XL11_0
    v_mfma_f32_16x16x32_bf16 v[104:107], v[200:203], v[116:119], v[104:107]
K1_XL11_0:
    s_waitcnt lgkmcnt(8)
    ds_read_b64_tr_b16 v[200:201], v208 offset:8192
    ds_read_b64_tr_b16 v[202:203], v208 offset:12288
    v_mfma_f32_16x16x32_bf16 v[96:99], v[180:183], v[108:111], v[96:99]
    v_mfma_f32_16x16x32_bf16 v[100:103], v[180:183], v[112:115], v[100:103]
    s_cmp_eq_u32 s28, 2
    s_cbranch_scc0 K1_XL12_0
    v_mfma_f32_16x16x32_bf16 v[104:107], v[180:183], v[116:119], v[104:107]
K1_XL12_0:
    s_waitcnt vmcnt(22)
    s_waitcnt lgkmcnt(8)
    ds_read_b64_tr_b16 v[180:181], v209 offset:8192
    ds_read_b64_tr_b16 v[182:183], v209 offset:12288
    v_mfma_f32_16x16x32_bf16 v[0:3], v[184:187], v[120:123], v[0:3]
    v_mfma_f32_16x16x32_bf16 v[4:7], v[184:187], v[124:127], v[4:7]
    buffer_load_dwordx4 v[108:111], v223, s[8:11], s36 offen offset:0
    s_waitcnt lgkmcnt(8)
    ds_read_b64_tr_b16 v[184:185], v210 offset:8192
    ds_read_b64_tr_b16 v[186:187], v210 offset:12288
    v_mfma_f32_16x16x32_bf16 v[8:11], v[188:191], v[120:123], v[8:11]
    v_mfma_f32_16x16x32_bf16 v[12:15], v[188:191], v[124:127], v[12:15]
    s_waitcnt lgkmcnt(8)
    ds_read_b64_tr_b16 v[188:189], v211 offset:8192
    ds_read_b64_tr_b16 v[190:191], v211 offset:12288
    v_mfma_f32_16x16x32_bf16 v[16:19], v[192:195], v[120:123], v[16:19]
    v_mfma_f32_16x16x32_bf16 v[20:23], v[192:195], v[124:127], v[20:23]
    buffer_load_dwordx4 v[112:115], v223, s[8:11], s36 offen offset:1024
    s_waitcnt lgkmcnt(8)
    ds_read_b64_tr_b16 v[192:193], v212 offset:1024
    ds_read_b64_tr_b16 v[194:195], v212 offset:1536
    v_mfma_f32_16x16x32_bf16 v[24:27], v[196:199], v[120:123], v[24:27]
    v_mfma_f32_16x16x32_bf16 v[28:31], v[196:199], v[124:127], v[28:31]
    s_waitcnt lgkmcnt(8)
    ds_read_b64_tr_b16 v[196:197], v213 offset:4096
    ds_read_b64_tr_b16 v[198:199], v213 offset:6144
    v_mfma_f32_16x16x32_bf16 v[32:35], v[200:203], v[120:123], v[32:35]
    v_mfma_f32_16x16x32_bf16 v[36:39], v[200:203], v[124:127], v[36:39]
    buffer_load_dwordx4 v[116:119], v225, s[8:11], s36 offen offset:0
    s_add_u32 s36, s36, 0x20000
    s_waitcnt lgkmcnt(8)
    ds_read_b64_tr_b16 v[200:201], v214 offset:4096
    ds_read_b64_tr_b16 v[202:203], v214 offset:6144
    v_mfma_f32_16x16x32_bf16 v[40:43], v[180:183], v[120:123], v[40:43]
    v_mfma_f32_16x16x32_bf16 v[44:47], v[180:183], v[124:127], v[44:47]
    s_waitcnt lgkmcnt(8)
    ds_read_b64_tr_b16 v[180:181], v215 offset:4096
    ds_read_b64_tr_b16 v[182:183], v215 offset:6144
    v_mfma_f32_16x16x32_bf16 v[48:51], v[184:187], v[120:123], v[48:51]
    v_mfma_f32_16x16x32_bf16 v[52:55], v[184:187], v[124:127], v[52:55]
    s_waitcnt lgkmcnt(8)
    ds_read_b64_tr_b16 v[184:185], v216 offset:4096
    ds_read_b64_tr_b16 v[186:187], v216 offset:6144
    v_mfma_f32_16x16x32_bf16 v[56:59], v[188:191], v[120:123], v[56:59]
    v_mfma_f32_16x16x32_bf16 v[60:63], v[188:191], v[124:127], v[60:63]
    s_add_u32 m0, s34, s39
    s_nop 0
    buffer_load_dwordx4 v219, s[12:15], s37 offen offset:2048 lds
    s_waitcnt lgkmcnt(8)
    ds_read_b64_tr_b16 v[188:189], v204 offset:16384
    ds_read_b64_tr_b16 v[190:191], v204 offset:20480
    v_mfma_f32_16x16x32_bf16 v[64:67], v[192:195], v[120:123], v[64:67]
    v_mfma_f32_16x16x32_bf16 v[68:71], v[192:195], v[124:127], v[68:71]
    s_waitcnt lgkmcnt(8)
    ds_read_b64_tr_b16 v[192:193], v205 offset:16384
    ds_read_b64_tr_b16 v[194:195], v205 offset:20480
    v_mfma_f32_16x16x32_bf16 v[72:75], v[196:199], v[120:123], v[72:75]
    v_mfma_f32_16x16x32_bf16 v[76:79], v[196:199], v[124:127], v[76:79]
    s_waitcnt lgkmcnt(8)
    ds_read_b64_tr_b16 v[196:197], v206 offset:16384
    ds_read_b64_tr_b16 v[198:199], v206 offset:20480
    v_mfma_f32_16x16x32_bf16 v[80:83], v[200:203], v[120:123], v[80:83]
    v_mfma_f32_16x16x32_bf16 v[84:87], v[200:203], v[124:127], v[84:87]
    s_cmp_eq_u32 s28, 0
    s_cbranch_scc0 K1_XL10_1
    v_mfma_f32_16x16x32_bf16 v[104:107], v[200:203], v[128:131], v[104:107]
K1_XL10_1:
    s_add_u32 m0, s34, s44
    s_mov_b32 exec_lo, 0xffffff
    s_mov_b32 exec_hi, 0
    buffer_load_dwordx4 v220, s[12:15], s37 offen offset:0 lds
    s_mov_b64 exec, -1
    s_waitcnt lgkmcnt(8)
    ds_read_b64_tr_b16 v[200:201], v207 offset:16384
    ds_read_b64_tr_b16 v[202:203], v207 offset:20480
    v_mfma_f32_16x16x32_bf16 v[88:91], v[180:183], v[120:123], v[88:91]
    v_mfma_f32_16x16x32_bf16 v[92:95], v[180:183], v[124:127], v[92:95]
    s_cmp_eq_u32 s28, 1
    s_cbranch_scc0 K1_XL11_1
    v_mfma_f32_16x16x32_bf16 v[104:107], v[180:183], v[128:131], v[104:107]
K1_XL11_1:
    s_waitcnt lgkmcnt(8)
    ds_read_b64_tr_b16 v[180:181], v208 offset:16384
    ds_read_b64_tr_b16 v[182:183], v208 offset:20480
    v_mfma_f32_16x16x32_bf16 v[96:99], v[184:187], v[120:123], v[96:99]
    v_mfma_f32_16x16x32_bf16 v[100:103], v[184:187], v[124:127], v[100:103]
    s_cmp_eq_u32 s28, 2
    s_cbranch_scc0 K1_XL12_1
    v_mfma_f32_16x16x32_bf16 v[104:107], v[184:187], v[128:131], v[104:107]
K1_XL12_1:
    s_waitcnt vmcnt(22)
    s_add_u32 s33, s33, 39936
    s_cmp_ge_u32 s33, 159744
    s_cselect_b32 s32, 159744, 0
    s_sub_u32 s33, s33, s32
    s_sub_u32 s32, 39936, s32
    s_waitcnt lgkmcnt(8)
    ds_read_b64_tr_b16 v[184:185], v209 offset:16384
    ds_read_b64_tr_b16 v[186:187], v209 offset:20480
    v_mfma_f32_16x16x32_bf16 v[0:3], v[188:191], v[132:135], v[0:3]
    v_mfma_f32_16x16x32_bf16 v[4:7], v[188:191], v[136:139], v[4:7]
    buffer_load_dwordx4 v[120:123], v223, s[8:11], s36 offen offset:0
    s_waitcnt lgkmcnt(8)
    ds_read_b64_tr_b16 v[188:189], v210 offset:16384
    ds_read_b64_tr_b16 v[190:191], v210 offset:20480
    v_mfma_f32_16x16x32_bf16 v[8:11], v[192:195], v[132:135], v[8:11]
    v_mfma_f32_16x16x32_bf16 v[12:15], v[192:195], v[136:139], v[12:15]
    s_waitcnt lgkmcnt(8)
    ds_read_b64_tr_b16 v[192:193], v211 offset:16384
    ds_read_b64_tr_b16 v[194:195], v211 offset:20480
    v_mfma_f32_16x16x32_bf16 v[16:19], v[196:199], v[132:135], v[16:19]
    v_mfma_f32_16x16x32_bf16 v[20:23], v[196:199], v[136:139], v[20:23]
    buffer_load_dwordx4 v[124:127], v223, s[8:11], s36 offen offset:1024
    s_waitcnt lgkmcnt(8)
    ds_read_b64_tr_b16 v[196:197], v212 offset:2048
    ds_read_b64_tr_b16 v[198:199], v212 offset:2560
    v_mfma_f32_16x16x32_bf16 v[24:27], v[200:203], v[132:135], v[24:27]
    v_mfma_f32_16x16x32_bf16 v[28:31], v[200:203], v[136:139], v[28:31]
    s_waitcnt lgkmcnt(8)
    ds_read_b64_tr_b16 v[200:201], v213 offset:8192
    ds_read_b64_tr_b16 v[202:203], v213 offset:10240
    v_mfma_f32_16x16x32_bf16 v[32:35], v[180:183], v[132:135], v[32:35]
    v_mfma_f32_16x16x32_bf16 v[36:39], v[180:183], v[136:139], v[36:39]
    buffer_load_dwordx4 v[128:131], v225, s[8:11], s36 offen offset:0
    s_add_u32 s36, s36, 0x20000
    s_waitcnt lgkmcnt(8)
    ds_read_b64_tr_b16 v[180:181], v214 offset:8192
    ds_read_b64_tr_b16 v[182:183], v214 offset:10240
    v_mfma_f32_16x16x32_bf16 v[40:43], v[184:187], v[132:135], v[40:43]
    v_mfma_f32_16x16x32_bf16 v[44:47], v[184:187], v[136:139], v[44:47]
    s_waitcnt lgkmcnt(8)
    ds_read_b64_tr_b16 v[184:185], v215 offset:8192
    ds_read_b64_tr_b16 v[186:187], v215 offset:10240
    v_mfma_f32_16x16x32_bf16 v[48:51], v[188:191], v[132:135], v[48:51]
    v_mfma_f32_16x16x32_bf16 v[52:55], v[188:191], v[136:139], v[52:55]
    s_waitcnt lgkmcnt(8)
    ds_read_b64_tr_b16 v[188:189], v216 offset:8192
    ds_read_b64_tr_b16 v[190:191], v216 offset:10240
    v_mfma_f32_16x16x32_bf16 v[56:59], v[192:195], v[132:135], v[56:59]
    v_mfma_f32_16x16x32_bf16 v[60:63], v[192:195], v[136:139], v[60:63]
    s_add_u32 m0, s34, s45
    s_nop 0
    buffer_load_dwordx4 v221, s[16:19], s38 offen offset:0 lds
    s_waitcnt lgkmcnt(8)
    s_barrier
    v_add_u32 v204, s32, v204
    ds_read_b64_tr_b16 v[192:193], v204 offset:0
    ds_read_b64_tr_b16 v[194:195], v204 offset:4096
    v_mfma_f32_16x16x32_bf16 v[64:67], v[196:199], v[132:135], v[64:67]
    v_mfma_f32_16x16x32_bf16 v[68:71], v[196:199], v[136:139], v[68:71]
    s_waitcnt lgkmcnt(8)
    v_add_u32 v205, s32, v205
    ds_read_b64_tr_b16 v[196:197], v205 offset:0
    ds_read_b64_tr_b16 v[198:199], v205 offset:4096
    v_mfma_f32_16x16x32_bf16 v[72:75], v[200:203], v[132:135], v[72:75]
    v_mfma_f32_16x16x32_bf16 v[76:79], v[200:203], v[136:139], v[76:79]
    s_waitcnt lgkmcnt(8)
    v_add_u32 v206, s32, v206
    ds_read_b64_tr_b16 v[200:201], v206 offset:0
    ds_read_b64_tr_b16 v[202:203], v206 offset:4096
    v_mfma_f32_16x16x32_bf16 v[80:83], v[180:183], v[132:135], v[80:83]
    v_mfma_f32_16x16x32_bf16 v[84:87], v[180:183], v[136:139], v[84:87]
    s_cmp_eq_u32 s28, 0
    s_cbranch_scc0 K1_XL10_2
    v_mfma_f32_16x16x32_bf16 v[104:107], v[180:183], v[140:143], v[104:107]
K1_XL10_2:
    s_add_u32 m0, s34, s45
    s_mov_b32 exec_lo, 0xffffffff
    s_mov_b32 exec_hi, 0
    buffer_load_dwordx4 v222, s[16:19], s38 offen offset:1024 lds
    s_mov_b64 exec, -1
    s_add_u32 s37, s37, 884736
    s_add_u32 s38, s38, 12288
    s_add_u32 s34, s34, 39936
    s_cmp_ge_u32 s34, 159744
    s_cselect_b32 s34, 0, s34
    s_waitcnt lgkmcnt(8)
    v_add_u32 v207, s32, v207
    ds_read_b64_tr_b16 v[180:181], v207 offset:0
    ds_read_b64_tr_b16 v[182:183], v207 offset:4096
    v_mfma_f32_16x16x32_bf16 v[88:91], v[184:187], v[132:135], v[88:91]
    v_mfma_f32_16x16x32_bf16 v[92:95], v[184:187], v[136:139], v[92:95]
    s_cmp_eq_u32 s28, 1
    s_cbranch_scc0 K1_XL11_2
    v_mfma_f32_16x16x32_bf16 v[104:107], v[184:187], v[140:143], v[104:107]
K1_XL11_2:
    s_waitcnt lgkmcnt(8)
    v_add_u32 v208, s32, v208
    ds_read_b64_tr_b16 v[184:185], v208 offset:0
    ds_read_b64_tr_b16 v[186:187], v208 offset:4096
    v_mfma_f32_16x16x32_bf16 v[96:99], v[188:191], v[132:135], v[96:99]
    v_mfma_f32_16x16x32_bf16 v[100:103], v[188:191], v[136:139], v[100:103]
    s_cmp_eq_u32 s28, 2
    s_cbranch_scc0 K1_XL12_2
    v_mfma_f32_16x16x32_bf16 v[104:107], v[188:191], v[140:143], v[104:107]
K1_XL12_2:
    s_sub_u32 s31, s31, 1
    s_cmp_lg_u32 s31, 0
    s_cbranch_scc0 K1_DONE
K1_MID:
    s_waitcnt vmcnt(22)
    s_waitcnt lgkmcnt(8)
    v_add_u32 v209, s32, v209
    ds_read_b64_tr_b16 v[188:189], v209 offset:0
    ds_read_b64_tr_b16 v[190:191], v209 offset:4096
    v_mfma_f32_16x16x32_bf16 v[0:3], v[192:195], v[144:147], v[0:3]
    v_mfma_f32_16x16x32_bf16 v[4:7], v[192:195], v[148:151], v[4:7]
    buffer_load_dwordx4 v[132:135], v223, s[8:11], s36 offen offset:0
    s_waitcnt lgkmcnt(8)
    v_add_u32 v210, s32, v210
    ds_read_b64_tr_b16 v[192:193], v210 offset:0
    ds_read_b64_tr_b16 v[194:195], v210 offset:4096
    v_mfma_f32_16x16x32_bf16 v[8:11], v[196:199], v[144:147], v[8:11]
    v_mfma_f32_16x16x32_bf16 v[12:15], v[196:199], v[148:151], v[12:15]
    s_waitcnt lgkmcnt(8)
    v_add_u32 v211, s32, v211
    ds_read_b64_tr_b16 v[196:197], v211 offset:0
    ds_read_b64_tr_b16 v[198:199], v211 offset:4096
    v_mfma_f32_16x16x32_bf16 v[16:19], v[200:203], v[144:147], v[16:19]
    v_mfma_f32_16x16x32_bf16 v[20:23], v[200:203], v[148:151], v[20:23]
    buffer_load_dwordx4 v[136:139], v223, s[8:11], s36 offen offset:1024
    s_waitcnt lgkmcnt(8)
    v_add_u32 v212, s32, v212
    ds_read_b64_tr_b16 v[200:201], v212 offset:0
    ds_read_b64_tr_b16 v[202:203], v212 offset:512
    v_mfma_f32_16x16x32_bf16 v[24:27], v[180:183], v[144:147], v[24:27]
    v_mfma_f32_16x16x32_bf16 v[28:31], v[180:183], v[148:151], v[28:31]
    s_waitcnt lgkmcnt(8)
    v_add_u32 v213, s32, v213
    ds_read_b64_tr_b16 v[180:181], v213 offset:0
    ds_read_b64_tr_b16 v[182:183], v213 offset:2048
    v_mfma_f32_16x16x32_bf16 v[32:35], v[184:187], v[144:147], v[32:35]
    v_mfma_f32_16x16x32_bf16 v[36:39], v[184:187], v[148:151], v[36:39]
    buffer_load_dwordx4 v[140:143], v225, s[8:11], s36 offen offset:0
    s_add_u32 s36, s36, 0x20000
    s_waitcnt lgkmcnt(8)
    v_add_u32 v214, s32, v214
    ds_read_b64_tr_b16 v[184:185], v214 offset:0
    ds_read_b64_tr_b16 v[186:187], v214 offset:2048
    v_mfma_f32_16x16x32_bf16 v[40:43], v[188:191], v[144:147], v[40:43]
    v_mfma_f32_16x16x32_bf16 v[44:47], v[188:191], v[148:151], v[44:47]
    s_waitcnt lgkmcnt(8)
    v_add_u32 v215, s32, v215
    ds_read_b64_tr_b16 v[188:189], v215 offset:0
    ds_read_b64_tr_b16 v[190:191], v215 offset:2048
    v_mfma_f32_16x16x32_bf16 v[48:51], v[192:195], v[144:147], v[48:51]
    v_mfma_f32_16x16x32_bf16 v[52:55], v[192:195], v[148:151], v[52:55]
    s_waitcnt lgkmcnt(8)
    v_add_u32 v216, s32, v216
    ds_read_b64_tr_b16 v[192:193], v216 offset:0
    ds_read_b64_tr_b16 v[194:195], v216 offset:2048
    v_mfma_f32_16x16x32_bf16 v[56:59], v[196:199], v[144:147], v[56:59]
    v_mfma_f32_16x16x32_bf16 v[60:63], v[196:199], v[148:151], v[60:63]
    s_add_u32 m0, s34, s39
    s_nop 0
    buffer_load_dwordx4 v217, s[12:15], s37 offen offset:0 lds
    s_waitcnt lgkmcnt(8)
    ds_read_b64_tr_b16 v[196:197], v204 offset:8192
    ds_read_b64_tr_b16 v[198:199], v204 offset:12288
    v_mfma_f32_16x16x32_bf16 v[64:67], v[200:203], v[144:147], v[64:67]
    v_mfma_f32_16x16x32_bf16 v[68:71], v[200:203], v[148:151], v[68:71]
    s_waitcnt lgkmcnt(8)
    ds_read_b64_tr_b16 v[200:201], v205 offset:8192
    ds_read_b64_tr_b16 v[202:203], v205 offset:12288
    v_mfma_f32_16x16x32_bf16 v[72:75], v[180:183], v[144:147], v[72:75]
    v_mfma_f32_16x16x32_bf16 v[76:79], v[180:183], v[148:151], v[76:79]
    s_waitcnt lgkmcnt(8)
    ds_read_b64_tr_b16 v[180:181], v206 offset:8192
    ds_read_b64_tr_b16 v[182:183], v206 offset:12288
    v_mfma_f32_16x16x32_bf16 v[80:83], v[184:187], v[144:147], v[80:83]
    v_mfma_f32_16x16x32_bf16 v[84:87], v[184:187], v[148:151], v[84:87]
    s_cmp_eq_u32 s28, 0
    s_cbranch_scc0 K1_XL10_3
    v_mfma_f32_16x16x32_bf16 v[104:107], v[184:187], v[152:155], v[104:107]
K1_XL10_3:
    s_add_u32 m0, s34, s39
    s_nop 0
    buffer_load_dwordx4 v218, s[12:15], s37 offen offset:1024 lds
    s_waitcnt lgkmcnt(8)
    ds_read_b64_tr_b16 v[184:185], v207 offset:8192
    ds_read_b64_tr_b16 v[186:187], v207 offset:12288
    v_mfma_f32_16x16x32_bf16 v[88:91], v[188:191], v[144:147], v[88:91]
    v_mfma_f32_16x16x32_bf16 v[92:95], v[188:191], v[148:151], v[92:95]
    s_cmp_eq_u32 s28, 1
    s_cbranch_scc0 K1_XL11_3
    v_mfma_f32_16x16x32_bf16 v[104:107], v[188:191], v[152:155], v[104:107]
K1_XL11_3:
    s_waitcnt lgkmcnt(8)
    ds_read_b64_tr_b16 v[188:189], v208 offset:8192
    ds_read_b64_tr_b16 v[190:191], v208 offset:12288
    v_mfma_f32_16x16x32_bf16 v[96:99], v[192:195], v[144:147], v[96:99]
    v_mfma_f32_16x16x32_bf16 v[100:103], v[192:195], v[148:151], v[100:103]
    s_cmp_eq_u32 s28, 2
    s_cbranch_scc0 K1_XL12_3
    v_mfma_f32_16x16x32_bf16 v[104:107], v[192:195], v[152:155], v[104:107]
K1_XL12_3:
    s_waitcnt vmcnt(22)
    s_waitcnt lgkmcnt(8)
    ds_read_b64_tr_b16 v[192:193], v209 offset:8192
    ds_read_b64_tr_b16 v[194:195], v209 offset:12288
    v_mfma_f32_16x16x32_bf16 v[0:3], v[196:199], v[156:159], v[0:3]
    v_mfma_f32_16x16x32_bf16 v[4:7], v[196:199], v[160:163], v[4:7]
    buffer_load_dwordx4 v[144:147], v223, s[8:11], s36 offen offset:0
    s_waitcnt lgkmcnt(8)
    ds_read_b64_tr_b16 v[196:197], v210 offset:8192
    ds_read_b64_tr_b16 v[198:199], v210 offset:12288
    v_mfma_f32_16x16x32_bf16 v[8:11], v[200:203], v[156:159], v[8:11]
    v_mfma_f32_16x16x32_bf16 v[12:15], v[200:203], v[160:163], v[12:15]
    s_waitcnt lgkmcnt(8)
    ds_read_b64_tr_b16 v[200:201], v211 offset:8192
    ds_read_b64_tr_b16 v[202:203], v211 offset:12288
    v_mfma_f32_16x16x32_bf16 v[16:19], v[180:183], v[156:159], v[16:19]
    v_mfma_f32_16x16x32_bf16 v[20:23], v[180:183], v[160:163], v[20:23]
    buffer_load_dwordx4 v[148:151], v223, s[8:11], s36 offen offset:1024
    s_waitcnt lgkmcnt(8)
    ds_read_b64_tr_b16 v[180:181], v212 offset:1024
    ds_read_b64_tr_b16 v[182:183], v212 offset:1536
    v_mfma_f32_16x16x32_bf16 v[24:27], v[184:187], v[156:159], v[24:27]
    v_mfma_f32_16x16x32_bf16 v[28:31], v[184:187], v[160:163], v[28:31]
    s_waitcnt lgkmcnt(8)
    ds_read_b64_tr_b16 v[184:185], v213 offset:4096
    ds_read_b64_tr_b16 v[186:187], v213 offset:6144
    v_mfma_f32_16x16x32_bf16 v[32:35], v[188:191], v[156:159], v[32:35]
    v_mfma_f32_16x16x32_bf16 v[36:39], v[188:191], v[160:163], v[36:39]
    buffer_load_dwordx4 v[152:155], v225, s[8:11], s36 offen offset:0
    s_add_u32 s36, s36, 0x20000
    s_waitcnt lgkmcnt(8)
    ds_read_b64_tr_b16 v[188:189], v214 offset:4096
    ds_read_b64_tr_b16 v[190:191], v214 offset:6144
    v_mfma_f32_16x16x32_bf16 v[40:43], v[192:195], v[156:159], v[40:43]
    v_mfma_f32_16x16x32_bf16 v[44:47], v[192:195], v[160:163], v[44:47]
    s_waitcnt lgkmcnt(8)
    ds_read_b64_tr_b16 v[192:193], v215 offset:4096
    ds_read_b64_tr_b16 v[194:195], v215 offset:6144
    v_mfma_f32_16x16x32_bf16 v[48:51], v[196:199], v[156:159], v[48:51]
    v_mfma_f32_16x16x32_bf16 v[52:55], v[196:199], v[160:163], v[52:55]
    s_waitcnt lgkmcnt(8)
    ds_read_b64_tr_b16 v[196:197], v216 offset:4096
    ds_read_b64_tr_b16 v[198:199], v216 offset:6144
    v_mfma_f32_16x16x32_bf16 v[56:59], v[200:203], v[156:159], v[56:59]
    v_mfma_f32_16x16x32_bf16 v[60:63], v[200:203], v[160:163], v[60:63]
    s_add_u32 m0, s34, s39
    s_nop 0
    buffer_load_dwordx4 v219, s[12:15], s37 offen offset:2048 lds
    s_waitcnt lgkmcnt(8)
    ds_read_b64_tr_b16 v[200:201], v204 offset:16384
    ds_read_b64_tr_b16 v[202:203], v204 offset:20480
    v_mfma_f32_16x16x32_bf16 v[64:67], v[180:183], v[156:159], v[64:67]
    v_mfma_f32_16x16x32_bf16 v[68:71], v[180:183], v[160:163], v[68:71]
    s_waitcnt lgkmcnt(8)
    ds_read_b64_tr_b16 v[180:181], v205 offset:16384
    ds_read_b64_tr_b16 v[182:183], v205 offset:20480
    v_mfma_f32_16x16x32_bf16 v[72:75], v[184:187], v[156:159], v[72:75]
    v_mfma_f32_16x16x32_bf16 v[76:79], v[184:187], v[160:163], v[76:79]
    s_waitcnt lgkmcnt(8)
    ds_read_b64_tr_b16 v[184:185], v206 offset:16384
    ds_read_b64_tr_b16 v[186:187], v206 offset:20480
    v_mfma_f32_16x16x32_bf16 v[80:83], v[188:191], v[156:159], v[80:83]
    v_mfma_f32_16x16x32_bf16 v[84:87], v[188:191], v[160:163], v[84:87]
    s_cmp_eq_u32 s28, 0
    s_cbranch_scc0 K1_XL10_4
    v_mfma_f32_16x16x32_bf16 v[104:107], v[188:191], v[164:167], v[104:107]
K1_XL10_4:
    s_add_u32 m0, s34, s44
    s_mov_b32 exec_lo, 0xffffff
    s_mov_b32 exec_hi, 0
    buffer_load_dwordx4 v220, s[12:15], s37 offen offset:0 lds
    s_mov_b64 exec, -1
    s_waitcnt lgkmcnt(8)
    ds_read_b64_tr_b16 v[188:189], v207 offset:16384
    ds_read_b64_tr_b16 v[190:191], v207 offset:20480
    v_mfma_f32_16x16x32_bf16 v[88:91], v[192:195], v[156:159], v[88:91]
    v_mfma_f32_16x16x32_bf16 v[92:95], v[192:195], v[160:163], v[92:95]
    s_cmp_eq_u32 s28, 1
    s_cbranch_scc0 K1_XL11_4
    v_mfma_f32_16x16x32_bf16 v[104:107], v[192:195], v[164:167], v[104:107]
K1_XL11_4:
    s_waitcnt lgkmcnt(8)
    ds_read_b64_tr_b16 v[192:193], v208 offset:16384
    ds_read_b64_tr_b16 v[194:195], v208 offset:20480
    v_mfma_f32_16x16x32_bf16 v[96:99], v[196:199], v[156:159], v[96:99]
    v_mfma_f32_16x16x32_bf16 v[100:103], v[196:199], v[160:163], v[100:103]
    s_cmp_eq_u32 s28, 2
    s_cbranch_scc0 K1_XL12_4
    v_mfma_f32_16x16x32_bf16 v[104:107], v[196:199], v[164:167], v[104:107]
K1_XL12_4:
    s_waitcnt vmcnt(22)
    s_add_u32 s33, s33, 39936
    s_cmp_ge_u32 s33, 159744
    s_cselect_b32 s32, 159744, 0
    s_sub_u32 s33, s33, s32
    s_sub_u32 s32, 39936, s32
    s_waitcnt lgkmcnt(8)
    ds_read_b64_tr_b16 v[196:197], v209 offset:16384
    ds_read_b64_tr_b16 v[198:199], v209 offset:20480
    v_mfma_f32_16x16x32_bf16 v[0:3], v[200:203], v[168:171], v[0:3]
    v_mfma_f32_16x16x32_bf16 v[4:7], v[200:203], v[172:175], v[4:7]
    buffer_load_dwordx4 v[156:159], v223, s[8:11], s36 offen offset:0
    s_waitcnt lgkmcnt(8)
    ds_read_b64_tr_b16 v[200:201], v210 offset:16384
    ds_read_b64_tr_b16 v[202:203], v210 offset:20480
    v_mfma_f32_16x16x32_bf16 v[8:11], v[180:183], v[168:171], v[8:11]
    v_mfma_f32_16x16x32_bf16 v[12:15], v[180:183], v[172:175], v[12:15]
    s_waitcnt lgkmcnt(8)
    ds_read_b64_tr_b16 v[180:181], v211 offset:16384
    ds_read_b64_tr_b16 v[182:183], v211 offset:20480
    v_mfma_f32_16x16x32_bf16 v[16:19], v[184:187], v[168:171], v[16:19]
    v_mfma_f32_16x16x32_bf16 v[20:23], v[184:187], v[172:175], v[20:23]
    buffer_load_dwordx4 v[160:163], v223, s[8:11], s36 offen offset:1024
    s_waitcnt lgkmcnt(8)
    ds_read_b64_tr_b16 v[184:185], v212 offset:2048
    ds_read_b64_tr_b16 v[186:187], v212 offset:2560
    v_mfma_f32_16x16x32_bf16 v[24:27], v[188:191], v[168:171], v[24:27]
    v_mfma_f32_16x16x32_bf16 v[28:31], v[188:191], v[172:175], v[28:31]
    s_waitcnt lgkmcnt(8)
    ds_read_b64_tr_b16 v[188:189], v213 offset:8192
    ds_read_b64_tr_b16 v[190:191], v213 offset:10240
    v_mfma_f32_16x16x32_bf16 v[32:35], v[192:195], v[168:171], v[32:35]
    v_mfma_f32_16x16x32_bf16 v[36:39], v[192:195], v[172:175], v[36:39]
    buffer_load_dwordx4 v[164:167], v225, s[8:11], s36 offen offset:0
    s_add_u32 s36, s36, 0x20000
    s_waitcnt lgkmcnt(8)
    ds_read_b64_tr_b16 v[192:193], v214 offset:8192
    ds_read_b64_tr_b16 v[194:195], v214 offset:10240
    v_mfma_f32_16x16x32_bf16 v[40:43], v[196:199], v[168:171], v[40:43]
    v_mfma_f32_16x16x32_bf16 v[44:47], v[196:199], v[172:175], v[44:47]
    s_waitcnt lgkmcnt(8)
    ds_read_b64_tr_b16 v[196:197], v215 offset:8192
    ds_read_b64_tr_b16 v[198:199], v215 offset:10240
    v_mfma_f32_16x16x32_bf16 v[48:51], v[200:203], v[168:171], v[48:51]
    v_mfma_f32_16x16x32_bf16 v[52:55], v[200:203], v[172:175], v[52:55]
    s_waitcnt lgkmcnt(8)
    ds_read_b64_tr_b16 v[200:201], v216 offset:8192
    ds_read_b64_tr_b16 v[202:203], v216 offset:10240
    v_mfma_f32_16x16x32_bf16 v[56:59], v[180:183], v[168:171], v[56:59]
    v_mfma_f32_16x16x32_bf16 v[60:63], v[180:183], v[172:175], v[60:63]
    s_add_u32 m0, s34, s45
    s_nop 0
    buffer_load_dwordx4 v221, s[16:19], s38 offen offset:0 lds
    s_waitcnt lgkmcnt(8)
    s_barrier
    v_add_u32 v204, s32, v204
    ds_read_b64_tr_b16 v[180:181], v204 offset:0
    ds_read_b64_tr_b16 v[182:183], v204 offset:4096
    v_mfma_f32_16x16x32_bf16 v[64:67], v[184:187], v[168:171], v[64:67]
    v_mfma_f32_16x16x32_bf16 v[68:71], v[184:187], v[172:175], v[68:71]
    s_waitcnt lgkmcnt(8)
    v_add_u32 v205, s32, v205
    ds_read_b64_tr_b16 v[184:185], v205 offset:0
    ds_read_b64_tr_b16 v[186:187], v205 offset:4096
    v_mfma_f32_16x16x32_bf16 v[72:75], v[188:191], v[168:171], v[72:75]
    v_mfma_f32_16x16x32_bf16 v[76:79], v[188:191], v[172:175], v[76:79]
    s_waitcnt lgkmcnt(8)
    v_add_u32 v206, s32, v206
    ds_read_b64_tr_b16 v[188:189], v206 offset:0
    ds_read_b64_tr_b16 v[190:191], v206 offset:4096
    v_mfma_f32_16x16x32_bf16 v[80:83], v[192:195], v[168:171], v[80:83]
    v_mfma_f32_16x16x32_bf16 v[84:87], v[192:195], v[172:175], v[84:87]
    s_cmp_eq_u32 s28, 0
    s_cbranch_scc0 K1_XL10_5
    v_mfma_f32_16x16x32_bf16 v[104:107], v[192:195], v[176:179], v[104:107]
K1_XL10_5:
    s_add_u32 m0, s34, s45
    s_mov_b32 exec_lo, 0xffffffff
    s_mov_b32 exec_hi, 0
    buffer_load_dwordx4 v222, s[16:19], s38 offen offset:1024 lds
    s_mov_b64 exec, -1
    s_add_u32 s37, s37, 884736
    s_add_u32 s38, s38, 12288
    s_add_u32 s34, s34, 39936
    s_cmp_ge_u32 s34, 159744
    s_cselect_b32 s34, 0, s34
    s_waitcnt lgkmcnt(8)
    v_add_u32 v207, s32, v207
    ds_read_b64_tr_b16 v[192:193], v207 offset:0
    ds_read_b64_tr_b16 v[194:195], v207 offset:4096
    v_mfma_f32_16x16x32_bf16 v[88:91], v[196:199], v[168:171], v[88:91]
    v_mfma_f32_16x16x32_bf16 v[92:95], v[196:199], v[172:175], v[92:95]
    s_cmp_eq_u32 s28, 1
    s_cbranch_scc0 K1_XL11_5
    v_mfma_f32_16x16x32_bf16 v[104:107], v[196:199], v[176:179], v[104:107]
K1_XL11_5:
    s_waitcnt lgkmcnt(8)
    v_add_u32 v208, s32, v208
    ds_read_b64_tr_b16 v[196:197], v208 offset:0
    ds_read_b64_tr_b16 v[198:199], v208 offset:4096
    v_mfma_f32_16x16x32_bf16 v[96:99], v[200:203], v[168:171], v[96:99]
    v_mfma_f32_16x16x32_bf16 v[100:103], v[200:203], v[172:175], v[100:103]
    s_cmp_eq_u32 s28, 2
    s_cbranch_scc0 K1_XL12_5
    v_mfma_f32_16x16x32_bf16 v[104:107], v[200:203], v[176:179], v[104:107]
K1_XL12_5:
    s_sub_u32 s31, s31, 1
    s_cmp_lg_u32 s31, 0
    s_cbranch_scc1 K1_LOOP
K1_DONE:
    s_waitcnt vmcnt(22)
    s_waitcnt lgkmcnt(8)
    v_add_u32 v209, s32, v209
    ds_read_b64_tr_b16 v[200:201], v209 offset:0
    ds_read_b64_tr_b16 v[202:203], v209 offset:4096
    v_mfma_f32_16x16x32_bf16 v[0:3], v[180:183], v[108:111], v[0:3]
    v_mfma_f32_16x16x32_bf16 v[4:7], v[180:183], v[112:115], v[4:7]
    buffer_load_dwordx4 v[168:171], v223, s[8:11], s36 offen offset:0
    s_waitcnt lgkmcnt(8)
    v_add_u32 v210, s32, v210
    ds_read_b64_tr_b16 v[180:181], v210 offset:0
    ds_read_b64_tr_b16 v[182:183], v210 offset:4096
    v_mfma_f32_16x16x32_bf16 v[8:11], v[184:187], v[108:111], v[8:11]
    v_mfma_f32_16x16x32_bf16 v[12:15], v[184:187], v[112:115], v[12:15]
    buffer_load_dwordx4 v[172:175], v223, s[8:11], s36 offen offset:1024
    s_waitcnt lgkmcnt(8)
    v_add_u32 v211, s32, v211
    ds_read_b64_tr_b16 v[184:185], v211 offset:0
    ds_read_b64_tr_b16 v[186:187], v211 offset:4096
    v_mfma_f32_16x16x32_bf16 v[16:19], v[188:191], v[108:111], v[16:19]
    v_mfma_f32_16x16x32_bf16 v[20:23], v[188:191], v[112:115], v[20:23]
    buffer_load_dwordx4 v[176:179], v225, s[8:11], s36 offen offset:0
    s_add_u32 s36, s36, 0x20000
    s_waitcnt lgkmcnt(8)
    v_add_u32 v212, s32, v212
    ds_read_b64_tr_b16 v[188:189], v212 offset:0
    ds_read_b64_tr_b16 v[190:191], v212 offset:512
    v_mfma_f32_16x16x32_bf16 v[24:27], v[192:195], v[108:111], v[24:27]
    v_mfma_f32_16x16x32_bf16 v[28:31], v[192:195], v[112:115], v[28:31]
    s_mul_i32 s40, s29, 9
    s_and_b32 s41, s29, 1
    s_add_u32 s47, s40, s41
    s_lshl_b32 s47, s47, 16
    s_xor_b32 s43, s41, 1
    s_lshl_b32 s43, s43, 3
    s_add_u32 s43, s43, s40
    s_lshr_b32 s43, s43, 1
    s_lshl_b32 s43, s43, 17
    s_lshl_b32 s41, s41, 9
    s_add_u32 s43, s43, s41
    s_add_u32 s48, s47, 131072
    s_add_u32 s49, s47, 262144
    s_add_u32 s50, s47, 393216
    s_lshl_b32 s40, s30, 4
    s_lshl_b32 s41, s28, 1
    s_add_u32 s41, s41, s40
    s_lshl_b32 s41, s41, 10
    v_and_b32 v253, 1, v227
    v_lshlrev_b32 v253, 10, v253
    v_lshl_add_u32 v253, v228, 4, v253
    v_lshrrev_b32 v248, 1, v227
    v_lshl_add_u32 v253, v248, 8, v253
    v_add_u32 v253, s41, v253
    s_mov_b32 s12, s58
    s_mov_b32 s13, s59
    s_mov_b32 s14, 0x510000
    s_mov_b32 s15, 0x00020000
    s_and_b32 s40, s2, 7
    s_mul_i32 s40, s40, 774144
    s_lshr_b32 s41, s2, 3
    s_mul_i32 s41, s41, 24192
    s_add_u32 s40, s40, s41
    v_min_u32 v248, 377, v229
    v_lshlrev_b32 v248, 6, v248
    buffer_load_dword v249, v248, s[12:15], s40 offen
    s_waitcnt lgkmcnt(8)
    v_add_u32 v213, s32, v213
    ds_read_b64_tr_b16 v[192:193], v213 offset:0
    ds_read_b64_tr_b16 v[194:195], v213 offset:2048
    v_mfma_f32_16x16x32_bf16 v[32:35], v[196:199], v[108:111], v[32:35]
    v_mfma_f32_16x16x32_bf16 v[36:39], v[196:199], v[112:115], v[36:39]
    s_waitcnt lgkmcnt(8)
    v_add_u32 v214, s32, v214
    ds_read_b64_tr_b16 v[196:197], v214 offset:0
    ds_read_b64_tr_b16 v[198:199], v214 offset:2048
    v_mfma_f32_16x16x32_bf16 v[40:43], v[200:203], v[108:111], v[40:43]
    v_mfma_f32_16x16x32_bf16 v[44:47], v[200:203], v[112:115], v[44:47]
    s_waitcnt lgkmcnt(8)
    v_add_u32 v215, s32, v215
    ds_read_b64_tr_b16 v[200:201], v215 offset:0
    ds_read_b64_tr_b16 v[202:203], v215 offset:2048
    v_mfma_f32_16x16x32_bf16 v[48:51], v[180:183], v[108:111], v[48:51]
    v_mfma_f32_16x16x32_bf16 v[52:55], v[180:183], v[112:115], v[52:55]
    s_waitcnt lgkmcnt(8)
    v_add_u32 v216, s32, v216
    ds_read_b64_tr_b16 v[180:181], v216 offset:0
    ds_read_b64_tr_b16 v[182:183], v216 offset:2048
    v_mfma_f32_16x16x32_bf16 v[56:59], v[184:187], v[108:111], v[56:59]
    v_mfma_f32_16x16x32_bf16 v[60:63], v[184:187], v[112:115], v[60:63]
    s_waitcnt lgkmcnt(8)
    ds_read_b64_tr_b16 v[184:185], v204 offset:8192
    ds_read_b64_tr_b16 v[186:187], v204 offset:12288
    v_mfma_f32_16x16x32_bf16 v[64:67], v[188:191], v[108:111], v[64:67]
    v_mfma_f32_16x16x32_bf16 v[68:71], v[188:191], v[112:115], v[68:71]
    s_waitcnt lgkmcnt(8)
    ds_read_b64_tr_b16 v[188:189], v205 offset:8192
    ds_read_b64_tr_b16 v[190:191], v205 offset:12288
    v_mfma_f32_16x16x32_bf16 v[72:75], v[192:195], v[108:111], v[72:75]
    v_mfma_f32_16x16x32_bf16 v[76:79], v[192:195], v[112:115], v[76:79]
    s_waitcnt lgkmcnt(8)
    ds_read_b64_tr_b16 v[192:193], v206 offset:8192
    ds_read_b64_tr_b16 v[194:195], v206 offset:12288
    v_mfma_f32_16x16x32_bf16 v[80:83], v[196:199], v[108:111], v[80:83]
    v_mfma_f32_16x16x32_bf16 v[84:87], v[196:199], v[112:115], v[84:87]
    s_cmp_eq_u32 s28, 0
    s_cbranch_scc0 K1_XT10_0
    v_mfma_f32_16x16x32_bf16 v[104:107], v[196:199], v[116:119], v[104:107]
K1_XT10_0:
    s_waitcnt lgkmcnt(8)
    ds_read_b64_tr_b16 v[196:197], v207 offset:8192
    ds_read_b64_tr_b16 v[198:199], v207 offset:12288
    v_mfma_f32_16x16x32_bf16 v[88:91], v[200:203], v[108:111], v[88:91]
    v_mfma_f32_16x16x32_bf16 v[92:95], v[200:203], v[112:115], v[92:95]
    s_cmp_eq_u32 s28, 1
    s_cbranch_scc0 K1_XT11_0
    v_mfma_f32_16x16x32_bf16 v[104:107], v[200:203], v[116:119], v[104:107]
K1_XT11_0:
    s_waitcnt lgkmcnt(8)
    ds_read_b64_tr_b16 v[200:201], v204 offset:16384
    ds_read_b64_tr_b16 v[202:203], v204 offset:20480
    v_mfma_f32_16x16x32_bf16 v[96:99], v[180:183], v[108:111], v[96:99]
    v_mfma_f32_16x16x32_bf16 v[100:103], v[180:183], v[112:115], v[100:103]
    s_cmp_eq_u32 s28, 2
    s_cbranch_scc0 K1_XT12_0
    v_mfma_f32_16x16x32_bf16 v[104:107], v[180:183], v[116:119], v[104:107]
K1_XT12_0:
    s_waitcnt vmcnt(21)
    s_waitcnt lgkmcnt(8)
    ds_read_b64_tr_b16 v[180:181], v205 offset:16384
    ds_read_b64_tr_b16 v[182:183], v205 offset:20480
    v_mfma_f32_16x16x32_bf16 v[0:3], v[184:187], v[120:123], v[0:3]
    v_mfma_f32_16x16x32_bf16 v[4:7], v[184:187], v[124:127], v[4:7]
    s_waitcnt lgkmcnt(8)
    ds_read_b64_tr_b16 v[184:185], v206 offset:16384
    ds_read_b64_tr_b16 v[186:187], v206 offset:20480
    v_mfma_f32_16x16x32_bf16 v[8:11], v[188:191], v[120:123], v[8:11]
    v_mfma_f32_16x16x32_bf16 v[12:15], v[188:191], v[124:127], v[12:15]
    s_waitcnt lgkmcnt(8)
    ds_read_b64_tr_b16 v[188:189], v207 offset:16384
    ds_read_b64_tr_b16 v[190:191], v207 offset:20480
    v_mfma_f32_16x16x32_bf16 v[16:19], v[192:195], v[120:123], v[16:19]
    v_mfma_f32_16x16x32_bf16 v[20:23], v[192:195], v[124:127], v[20:23]
    s_waitcnt lgkmcnt(8)
    s_add_u32 s33, s33, 39936
    s_cmp_ge_u32 s33, 159744
    s_cselect_b32 s32, 159744, 0
    s_sub_u32 s33, s33, s32
    s_sub_u32 s32, 39936, s32
    s_waitcnt vmcnt(19)
    s_barrier
    v_add_u32 v204, s32, v204
    ds_read_b64_tr_b16 v[192:193], v204 offset:0
    ds_read_b64_tr_b16 v[194:195], v204 offset:4096
    v_mfma_f32_16x16x32_bf16 v[24:27], v[196:199], v[120:123], v[24:27]
    v_mfma_f32_16x16x32_bf16 v[28:31], v[196:199], v[124:127], v[28:31]
    s_waitcnt vmcnt(16)
    s_waitcnt lgkmcnt(8)
    v_add_u32 v205, s32, v205
    ds_read_b64_tr_b16 v[196:197], v205 offset:0
    ds_read_b64_tr_b16 v[198:199], v205 offset:4096
    v_mfma_f32_16x16x32_bf16 v[0:3], v[200:203], v[132:135], v[0:3]
    v_mfma_f32_16x16x32_bf16 v[4:7], v[200:203], v[136:139], v[4:7]
    s_waitcnt lgkmcnt(8)
    v_add_u32 v206, s32, v206
    ds_read_b64_tr_b16 v[200:201], v206 offset:0
    ds_read_b64_tr_b16 v[202:203], v206 offset:4096
    v_mfma_f32_16x16x32_bf16 v[8:11], v[180:183], v[132:135], v[8:11]
    v_mfma_f32_16x16x32_bf16 v[12:15], v[180:183], v[136:139], v[12:15]
    s_waitcnt lgkmcnt(8)
    v_add_u32 v207, s32, v207
    ds_read_b64_tr_b16 v[180:181], v207 offset:0
    ds_read_b64_tr_b16 v[182:183], v207 offset:4096
    v_mfma_f32_16x16x32_bf16 v[16:19], v[184:187], v[132:135], v[16:19]
    v_mfma_f32_16x16x32_bf16 v[20:23], v[184:187], v[136:139], v[20:23]
    s_waitcnt lgkmcnt(8)
    ds_read_b64_tr_b16 v[184:185], v204 offset:8192
    ds_read_b64_tr_b16 v[186:187], v204 offset:12288
    v_mfma_f32_16x16x32_bf16 v[24:27], v[188:191], v[132:135], v[24:27]
    v_mfma_f32_16x16x32_bf16 v[28:31], v[188:191], v[136:139], v[28:31]
    s_waitcnt vmcnt(11)
    s_waitcnt lgkmcnt(8)
    ds_read_b64_tr_b16 v[188:189], v205 offset:8192
    ds_read_b64_tr_b16 v[190:191], v205 offset:12288
    v_mfma_f32_16x16x32_bf16 v[0:3], v[192:195], v[144:147], v[0:3]
    v_mfma_f32_16x16x32_bf16 v[4:7], v[192:195], v[148:151], v[4:7]
    s_waitcnt lgkmcnt(8)
    ds_read_b64_tr_b16 v[192:193], v206 offset:8192
    ds_read_b64_tr_b16 v[194:195], v206 offset:12288
    v_mfma_f32_16x16x32_bf16 v[8:11], v[196:199], v[144:147], v[8:11]
    v_mfma_f32_16x16x32_bf16 v[12:15], v[196:199], v[148:151], v[12:15]
    s_waitcnt lgkmcnt(8)
    ds_read_b64_tr_b16 v[196:197], v207 offset:8192
    ds_read_b64_tr_b16 v[198:199], v207 offset:12288
    v_mfma_f32_16x16x32_bf16 v[16:19], v[200:203], v[144:147], v[16:19]
    v_mfma_f32_16x16x32_bf16 v[20:23], v[200:203], v[148:151], v[20:23]
    s_waitcnt lgkmcnt(8)
    ds_read_b64_tr_b16 v[200:201], v204 offset:16384
    ds_read_b64_tr_b16 v[202:203], v204 offset:20480
    v_mfma_f32_16x16x32_bf16 v[24:27], v[180:183], v[144:147], v[24:27]
    v_mfma_f32_16x16x32_bf16 v[28:31], v[180:183], v[148:151], v[28:31]
    s_waitcnt vmcnt(6)
    s_waitcnt lgkmcnt(8)
    ds_read_b64_tr_b16 v[180:181], v205 offset:16384
    ds_read_b64_tr_b16 v[182:183], v205 offset:20480
    v_mfma_f32_16x16x32_bf16 v[0:3], v[184:187], v[156:159], v[0:3]
    v_mfma_f32_16x16x32_bf16 v[4:7], v[184:187], v[160:163], v[4:7]
    s_waitcnt lgkmcnt(8)
    ds_read_b64_tr_b16 v[184:185], v206 offset:16384
    ds_read_b64_tr_b16 v[186:187], v206 offset:20480
    v_mfma_f32_16x16x32_bf16 v[8:11], v[188:191], v[156:159], v[8:11]
    v_mfma_f32_16x16x32_bf16 v[12:15], v[188:191], v[160:163], v[12:15]
    s_waitcnt lgkmcnt(8)
    ds_read_b64_tr_b16 v[188:189], v207 offset:16384
    ds_read_b64_tr_b16 v[190:191], v207 offset:20480
    v_mfma_f32_16x16x32_bf16 v[16:19], v[192:195], v[156:159], v[16:19]
    v_mfma_f32_16x16x32_bf16 v[20:23], v[192:195], v[160:163], v[20:23]
    s_waitcnt lgkmcnt(8)
    ds_read_b64_tr_b16 v[192:193], v208 offset:8192
    ds_read_b64_tr_b16 v[194:195], v208 offset:12288
    v_mfma_f32_16x16x32_bf16 v[24:27], v[196:199], v[156:159], v[24:27]
    v_mfma_f32_16x16x32_bf16 v[28:31], v[196:199], v[160:163], v[28:31]
    s_waitcnt vmcnt(1)
    s_waitcnt lgkmcnt(8)
    ds_read_b64_tr_b16 v[196:197], v209 offset:8192
    ds_read_b64_tr_b16 v[198:199], v209 offset:12288
    v_mfma_f32_16x16x32_bf16 v[0:3], v[200:203], v[168:171], v[0:3]
    v_mfma_f32_16x16x32_bf16 v[4:7], v[200:203], v[172:175], v[4:7]
    s_waitcnt lgkmcnt(8)
    ds_read_b64_tr_b16 v[200:201], v208 offset:16384
    ds_read_b64_tr_b16 v[202:203], v208 offset:20480
    v_mfma_f32_16x16x32_bf16 v[8:11], v[180:183], v[168:171], v[8:11]
    v_mfma_f32_16x16x32_bf16 v[12:15], v[180:183], v[172:175], v[12:15]
    s_waitcnt lgkmcnt(8)
    ds_read_b64_tr_b16 v[180:181], v209 offset:16384
    ds_read_b64_tr_b16 v[182:183], v209 offset:20480
    v_mfma_f32_16x16x32_bf16 v[16:19], v[184:187], v[168:171], v[16:19]
    v_mfma_f32_16x16x32_bf16 v[20:23], v[184:187], v[172:175], v[20:23]
    s_waitcnt lgkmcnt(8)
    v_add_u32 v208, s32, v208
    ds_read_b64_tr_b16 v[184:185], v208 offset:0
    ds_read_b64_tr_b16 v[186:187], v208 offset:4096
    v_mfma_f32_16x16x32_bf16 v[24:27], v[188:191], v[168:171], v[24:27]
    v_mfma_f32_16x16x32_bf16 v[28:31], v[188:191], v[172:175], v[28:31]
    s_waitcnt lgkmcnt(8)
    v_add_u32 v209, s32, v209
    ds_read_b64_tr_b16 v[188:189], v209 offset:0
    ds_read_b64_tr_b16 v[190:191], v209 offset:4096
    v_mfma_f32_16x16x32_bf16 v[32:35], v[192:195], v[120:123], v[32:35]
    v_mfma_f32_16x16x32_bf16 v[36:39], v[192:195], v[124:127], v[36:39]
    s_waitcnt lgkmcnt(8)
    ds_read_b64_tr_b16 v[192:193], v208 offset:8192
    ds_read_b64_tr_b16 v[194:195], v208 offset:12288
    v_mfma_f32_16x16x32_bf16 v[40:43], v[196:199], v[120:123], v[40:43]
    v_mfma_f32_16x16x32_bf16 v[44:47], v[196:199], v[124:127], v[44:47]
    v_cvt_pk_bf16_f32 v0, v0, v1
    v_cvt_pk_bf16_f32 v1, v2, v3
    v_cvt_pk_bf16_f32 v2, v4, v5
    v_cvt_pk_bf16_f32 v3, v6, v7
    v_pk_max_i16 v0, v0, 0
    v_pk_max_i16 v1, v1, 0
    v_pk_max_i16 v2, v2, 0
    v_pk_max_i16 v3, v3, 0
    v_cvt_pk_bf16_f32 v8, v8, v9
    v_cvt_pk_bf16_f32 v9, v10, v11
    v_cvt_pk_bf16_f32 v10, v12, v13
    v_cvt_pk_bf16_f32 v11, v14, v15
    v_pk_max_i16 v8, v8, 0
    v_pk_max_i16 v9, v9, 0
    v_pk_max_i16 v10, v10, 0
    v_pk_max_i16 v11, v11, 0
    v_cvt_pk_bf16_f32 v16, v16, v17
    v_cvt_pk_bf16_f32 v17, v18, v19
    v_cvt_pk_bf16_f32 v18, v20, v21
    v_cvt_pk_bf16_f32 v19, v22, v23
    v_pk_max_i16 v16, v16, 0
    v_pk_max_i16 v17, v17, 0
    v_pk_max_i16 v18, v18, 0
    v_pk_max_i16 v19, v19, 0
    v_cvt_pk_bf16_f32 v24, v24, v25
    v_cvt_pk_bf16_f32 v25, v26, v27
    v_cvt_pk_bf16_f32 v26, v28, v29
    v_cvt_pk_bf16_f32 v27, v30, v31
    v_pk_max_i16 v24, v24, 0
    v_pk_max_i16 v25, v25, 0
    v_pk_max_i16 v26, v26, 0
    v_pk_max_i16 v27, v27, 0
    s_nop 1
    v_permlane16_swap_b32 v0, v2
    v_permlane16_swap_b32 v1, v3
    v_permlane16_swap_b32 v8, v10
    v_permlane16_swap_b32 v9, v11
    v_permlane16_swap_b32 v16, v18
    v_permlane16_swap_b32 v17, v19
    v_permlane16_swap_b32 v24, v26
    v_permlane16_swap_b32 v25, v27
    s_nop 1
    buffer_store_dwordx4 v[0:3], v253, s[20:23], s47 offen offset:0 sc1
    buffer_store_dwordx4 v[8:11], v253, s[20:23], s47 offen offset:512 sc1
    buffer_store_dwordx4 v[16:19], v253, s[20:23], s48 offen offset:0 sc1
    buffer_store_dwordx4 v[24:27], v253, s[20:23], s48 offen offset:512 sc1
    s_waitcnt lgkmcnt(8)
    ds_read_b64_tr_b16 v[196:197], v209 offset:8192
    ds_read_b64_tr_b16 v[198:199], v209 offset:12288
    v_mfma_f32_16x16x32_bf16 v[32:35], v[200:203], v[132:135], v[32:35]
    v_mfma_f32_16x16x32_bf16 v[36:39], v[200:203], v[136:139], v[36:39]
    s_waitcnt lgkmcnt(8)
    ds_read_b64_tr_b16 v[200:201], v208 offset:16384
    ds_read_b64_tr_b16 v[202:203], v208 offset:20480
    v_mfma_f32_16x16x32_bf16 v[40:43], v[180:183], v[132:135], v[40:43]
    v_mfma_f32_16x16x32_bf16 v[44:47], v[180:183], v[136:139], v[44:47]
    s_waitcnt lgkmcnt(8)
    ds_read_b64_tr_b16 v[180:181], v209 offset:16384
    ds_read_b64_tr_b16 v[182:183], v209 offset:20480
    v_mfma_f32_16x16x32_bf16 v[32:35], v[184:187], v[144:147], v[32:35]
    v_mfma_f32_16x16x32_bf16 v[36:39], v[184:187], v[148:151], v[36:39]
    s_waitcnt lgkmcnt(8)
    ds_read_b64_tr_b16 v[184:185], v210 offset:8192
    ds_read_b64_tr_b16 v[186:187], v210 offset:12288
    v_mfma_f32_16x16x32_bf16 v[40:43], v[188:191], v[144:147], v[40:43]
    v_mfma_f32_16x16x32_bf16 v[44:47], v[188:191], v[148:151], v[44:47]
    s_waitcnt lgkmcnt(8)
    ds_read_b64_tr_b16 v[188:189], v211 offset:8192
    ds_read_b64_tr_b16 v[190:191], v211 offset:12288
    v_mfma_f32_16x16x32_bf16 v[32:35], v[192:195], v[156:159], v[32:35]
    v_mfma_f32_16x16x32_bf16 v[36:39], v[192:195], v[160:163], v[36:39]
    s_waitcnt lgkmcnt(8)
    ds_read_b64_tr_b16 v[192:193], v212 offset:1024
    ds_read_b64_tr_b16 v[194:195], v212 offset:1536
    v_mfma_f32_16x16x32_bf16 v[40:43], v[196:199], v[156:159], v[40:43]
    v_mfma_f32_16x16x32_bf16 v[44:47], v[196:199], v[160:163], v[44:47]
    s_waitcnt lgkmcnt(8)
    ds_read_b64_tr_b16 v[196:197], v210 offset:16384
    ds_read_b64_tr_b16 v[198:199], v210 offset:20480
    v_mfma_f32_16x16x32_bf16 v[32:35], v[200:203], v[168:171], v[32:35]
    v_mfma_f32_16x16x32_bf16 v[36:39], v[200:203], v[172:175], v[36:39]
    s_waitcnt lgkmcnt(8)
    ds_read_b64_tr_b16 v[200:201], v211 offset:16384
    ds_read_b64_tr_b16 v[202:203], v211 offset:20480
    v_mfma_f32_16x16x32_bf16 v[40:43], v[180:183], v[168:171], v[40:43]
    v_mfma_f32_16x16x32_bf16 v[44:47], v[180:183], v[172:175], v[44:47]
    s_waitcnt lgkmcnt(8)
    ds_read_b64_tr_b16 v[180:181], v212 offset:2048
    ds_read_b64_tr_b16 v[182:183], v212 offset:2560
    v_mfma_f32_16x16x32_bf16 v[48:51], v[184:187], v[120:123], v[48:51]
    v_mfma_f32_16x16x32_bf16 v[52:55], v[184:187], v[124:127], v[52:55]
    s_waitcnt lgkmcnt(8)
    v_add_u32 v210, s32, v210
    ds_read_b64_tr_b16 v[184:185], v210 offset:0
    ds_read_b64_tr_b16 v[186:187], v210 offset:4096
    v_mfma_f32_16x16x32_bf16 v[56:59], v[188:191], v[120:123], v[56:59]
    v_mfma_f32_16x16x32_bf16 v[60:63], v[188:191], v[124:127], v[60:63]
    v_cvt_pk_bf16_f32 v32, v32, v33
    v_cvt_pk_bf16_f32 v33, v34, v35
    v_cvt_pk_bf16_f32 v34, v36, v37
    v_cvt_pk_bf16_f32 v35, v38, v39
    v_pk_max_i16 v32, v32, 0
    v_pk_max_i16 v33, v33, 0
    v_pk_max_i16 v34, v34, 0
    v_pk_max_i16 v35, v35, 0
    v_cvt_pk_bf16_f32 v40, v40, v41
    v_cvt_pk_bf16_f32 v41, v42, v43
    v_cvt_pk_bf16_f32 v42, v44, v45
    v_cvt_pk_bf16_f32 v43, v46, v47
    v_pk_max_i16 v40, v40, 0
    v_pk_max_i16 v41, v41, 0
    v_pk_max_i16 v42, v42, 0
    v_pk_max_i16 v43, v43, 0
    s_nop 1
    v_permlane16_swap_b32 v32, v34
    v_permlane16_swap_b32 v33, v35
    v_permlane16_swap_b32 v40, v42
    v_permlane16_swap_b32 v41, v43
    s_nop 1
    buffer_store_dwordx4 v[32:35], v253, s[20:23], s49 offen offset:0 sc1
    buffer_store_dwordx4 v[40:43], v253, s[20:23], s49 offen offset:512 sc1
    s_waitcnt lgkmcnt(8)
    v_add_u32 v211, s32, v211
    ds_read_b64_tr_b16 v[188:189], v211 offset:0
    ds_read_b64_tr_b16 v[190:191], v211 offset:4096
    v_mfma_f32_16x16x32_bf16 v[64:67], v[192:195], v[120:123], v[64:67]
    v_mfma_f32_16x16x32_bf16 v[68:71], v[192:195], v[124:127], v[68:71]
    s_waitcnt lgkmcnt(8)
    v_add_u32 v212, s32, v212
    ds_read_b64_tr_b16 v[192:193], v212 offset:0
    ds_read_b64_tr_b16 v[194:195], v212 offset:512
    v_mfma_f32_16x16x32_bf16 v[48:51], v[196:199], v[132:135], v[48:51]
    v_mfma_f32_16x16x32_bf16 v[52:55], v[196:199], v[136:139], v[52:55]
    s_waitcnt lgkmcnt(8)
    ds_read_b64_tr_b16 v[196:197], v210 offset:8192
    ds_read_b64_tr_b16 v[198:199], v210 offset:12288
    v_mfma_f32_16x16x32_bf16 v[56:59], v[200:203], v[132:135], v[56:59]
    v_mfma_f32_16x16x32_bf16 v[60:63], v[200:203], v[136:139], v[60:63]
    s_waitcnt lgkmcnt(8)
    ds_read_b64_tr_b16 v[200:201], v211 offset:8192
    ds_read_b64_tr_b16 v[202:203], v211 offset:12288
    v_mfma_f32_16x16x32_bf16 v[64:67], v[180:183], v[132:135], v[64:67]
    v_mfma_f32_16x16x32_bf16 v[68:71], v[180:183], v[136:139], v[68:71]
    s_waitcnt lgkmcnt(8)
    ds_read_b64_tr_b16 v[180:181], v212 offset:1024
    ds_read_b64_tr_b16 v[182:183], v212 offset:1536
    v_mfma_f32_16x16x32_bf16 v[48:51], v[184:187], v[144:147], v[48:51]
    v_mfma_f32_16x16x32_bf16 v[52:55], v[184:187], v[148:151], v[52:55]
    s_waitcnt lgkmcnt(8)
    ds_read_b64_tr_b16 v[184:185], v210 offset:16384
    ds_read_b64_tr_b16 v[186:187], v210 offset:20480
    v_mfma_f32_16x16x32_bf16 v[56:59], v[188:191], v[144:147], v[56:59]
    v_mfma_f32_16x16x32_bf16 v[60:63], v[188:191], v[148:151], v[60:63]
    s_waitcnt lgkmcnt(8)
    ds_read_b64_tr_b16 v[188:189], v211 offset:16384
    ds_read_b64_tr_b16 v[190:191], v211 offset:20480
    v_mfma_f32_16x16x32_bf16 v[64:67], v[192:195], v[144:147], v[64:67]
    v_mfma_f32_16x16x32_bf16 v[68:71], v[192:195], v[148:151], v[68:71]
    s_waitcnt lgkmcnt(8)
    ds_read_b64_tr_b16 v[192:193], v212 offset:2048
    ds_read_b64_tr_b16 v[194:195], v212 offset:2560
    v_mfma_f32_16x16x32_bf16 v[48:51], v[196:199], v[156:159], v[48:51]
    v_mfma_f32_16x16x32_bf16 v[52:55], v[196:199], v[160:163], v[52:55]
    s_waitcnt lgkmcnt(8)
    ds_read_b64_tr_b16 v[196:197], v213 offset:4096
    ds_read_b64_tr_b16 v[198:199], v213 offset:6144
    v_mfma_f32_16x16x32_bf16 v[56:59], v[200:203], v[156:159], v[56:59]
    v_mfma_f32_16x16x32_bf16 v[60:63], v[200:203], v[160:163], v[60:63]
    s_waitcnt lgkmcnt(8)
    ds_read_b64_tr_b16 v[200:201], v214 offset:4096
    ds_read_b64_tr_b16 v[202:203], v214 offset:6144
    v_mfma_f32_16x16x32_bf16 v[64:67], v[180:183], v[156:159], v[64:67]
    v_mfma_f32_16x16x32_bf16 v[68:71], v[180:183], v[160:163], v[68:71]
    s_waitcnt lgkmcnt(8)
    ds_read_b64_tr_b16 v[180:181], v213 offset:8192
    ds_read_b64_tr_b16 v[182:183], v213 offset:10240
    v_mfma_f32_16x16x32_bf16 v[48:51], v[184:187], v[168:171], v[48:51]
    v_mfma_f32_16x16x32_bf16 v[52:55], v[184:187], v[172:175], v[52:55]
    s_waitcnt lgkmcnt(8)
    ds_read_b64_tr_b16 v[184:185], v214 offset:8192
    ds_read_b64_tr_b16 v[186:187], v214 offset:10240
    v_mfma_f32_16x16x32_bf16 v[56:59], v[188:191], v[168:171], v[56:59]
    v_mfma_f32_16x16x32_bf16 v[60:63], v[188:191], v[172:175], v[60:63]
    s_waitcnt lgkmcnt(8)
    v_add_u32 v213, s32, v213
    ds_read_b64_tr_b16 v[188:189], v213 offset:0
    ds_read_b64_tr_b16 v[190:191], v213 offset:2048
    v_mfma_f32_16x16x32_bf16 v[64:67], v[192:195], v[168:171], v[64:67]
    v_mfma_f32_16x16x32_bf16 v[68:71], v[192:195], v[172:175], v[68:71]
    s_waitcnt lgkmcnt(8)
    v_add_u32 v214, s32, v214
    ds_read_b64_tr_b16 v[192:193], v214 offset:0
    ds_read_b64_tr_b16 v[194:195], v214 offset:2048
    v_mfma_f32_16x16x32_bf16 v[72:75], v[196:199], v[120:123], v[72:75]
    v_mfma_f32_16x16x32_bf16 v[76:79], v[196:199], v[124:127], v[76:79]
    s_waitcnt lgkmcnt(8)
    ds_read_b64_tr_b16 v[196:197], v213 offset:4096
    ds_read_b64_tr_b16 v[198:199], v213 offset:6144
    v_mfma_f32_16x16x32_bf16 v[80:83], v[200:203], v[120:123], v[80:83]
    v_mfma_f32_16x16x32_bf16 v[84:87], v[200:203], v[124:127], v[84:87]
    s_cmp_eq_u32 s28, 0
    s_cbranch_scc0 K1_XT10_1
    v_mfma_f32_16x16x32_bf16 v[104:107], v[200:203], v[128:131], v[104:107]
K1_XT10_1:
    v_cvt_pk_bf16_f32 v48, v48, v49
    v_cvt_pk_bf16_f32 v49, v50, v51
    v_cvt_pk_bf16_f32 v50, v52, v53
    v_cvt_pk_bf16_f32 v51, v54, v55
    v_pk_max_i16 v48, v48, 0
    v_pk_max_i16 v49, v49, 0
    v_pk_max_i16 v50, v50, 0
    v_pk_max_i16 v51, v51, 0
    v_cvt_pk_bf16_f32 v56, v56, v57
    v_cvt_pk_bf16_f32 v57, v58, v59
    v_cvt_pk_bf16_f32 v58, v60, v61
    v_cvt_pk_bf16_f32 v59, v62, v63
    v_pk_max_i16 v56, v56, 0
    v_pk_max_i16 v57, v57, 0
    v_pk_max_i16 v58, v58, 0
    v_pk_max_i16 v59, v59, 0
    v_cvt_pk_bf16_f32 v64, v64, v65
    v_cvt_pk_bf16_f32 v65, v66, v67
    v_cvt_pk_bf16_f32 v66, v68, v69
    v_cvt_pk_bf16_f32 v67, v70, v71
    v_pk_max_i16 v64, v64, 0
    v_pk_max_i16 v65, v65, 0
    v_pk_max_i16 v66, v66, 0
    v_pk_max_i16 v67, v67, 0
    s_nop 1
    v_permlane16_swap_b32 v48, v50
    v_permlane16_swap_b32 v49, v51
    v_permlane16_swap_b32 v56, v58
    v_permlane16_swap_b32 v57, v59
    v_permlane16_swap_b32 v64, v66
    v_permlane16_swap_b32 v65, v67
    s_nop 1
    buffer_store_dwordx4 v[48:51], v253, s[20:23], s50 offen offset:0 sc1
    buffer_store_dwordx4 v[56:59], v253, s[20:23], s50 offen offset:512 sc1
    buffer_store_dwordx4 v[64:67], v253, s[20:23], s43 offen offset:0 sc1
    s_waitcnt lgkmcnt(8)
    ds_read_b64_tr_b16 v[200:201], v214 offset:4096
    ds_read_b64_tr_b16 v[202:203], v214 offset:6144
    v_mfma_f32_16x16x32_bf16 v[72:75], v[180:183], v[132:135], v[72:75]
    v_mfma_f32_16x16x32_bf16 v[76:79], v[180:183], v[136:139], v[76:79]
    s_waitcnt lgkmcnt(8)
    ds_read_b64_tr_b16 v[180:181], v213 offset:8192
    ds_read_b64_tr_b16 v[182:183], v213 offset:10240
    v_mfma_f32_16x16x32_bf16 v[80:83], v[184:187], v[132:135], v[80:83]
    v_mfma_f32_16x16x32_bf16 v[84:87], v[184:187], v[136:139], v[84:87]
    s_cmp_eq_u32 s28, 0
    s_cbranch_scc0 K1_XT10_2
    v_mfma_f32_16x16x32_bf16 v[104:107], v[184:187], v[140:143], v[104:107]
K1_XT10_2:
    s_waitcnt lgkmcnt(8)
    ds_read_b64_tr_b16 v[184:185], v214 offset:8192
    ds_read_b64_tr_b16 v[186:187], v214 offset:10240
    v_mfma_f32_16x16x32_bf16 v[72:75], v[188:191], v[144:147], v[72:75]
    v_mfma_f32_16x16x32_bf16 v[76:79], v[188:191], v[148:151], v[76:79]
    s_waitcnt lgkmcnt(8)
    ds_read_b64_tr_b16 v[188:189], v215 offset:4096
    ds_read_b64_tr_b16 v[190:191], v215 offset:6144
    v_mfma_f32_16x16x32_bf16 v[80:83], v[192:195], v[144:147], v[80:83]
    v_mfma_f32_16x16x32_bf16 v[84:87], v[192:195], v[148:151], v[84:87]
    s_cmp_eq_u32 s28, 0
    s_cbranch_scc0 K1_XT10_3
    v_mfma_f32_16x16x32_bf16 v[104:107], v[192:195], v[152:155], v[104:107]
K1_XT10_3:
    s_waitcnt lgkmcnt(8)
    ds_read_b64_tr_b16 v[192:193], v216 offset:4096
    ds_read_b64_tr_b16 v[194:195], v216 offset:6144
    v_mfma_f32_16x16x32_bf16 v[72:75], v[196:199], v[156:159], v[72:75]
    v_mfma_f32_16x16x32_bf16 v[76:79], v[196:199], v[160:163], v[76:79]
    s_waitcnt lgkmcnt(8)
    ds_read_b64_tr_b16 v[196:197], v215 offset:8192
    ds_read_b64_tr_b16 v[198:199], v215 offset:10240
    v_mfma_f32_16x16x32_bf16 v[80:83], v[200:203], v[156:159], v[80:83]
    v_mfma_f32_16x16x32_bf16 v[84:87], v[200:203], v[160:163], v[84:87]
    s_cmp_eq_u32 s28, 0
    s_cbranch_scc0 K1_XT10_4
    v_mfma_f32_16x16x32_bf16 v[104:107], v[200:203], v[164:167], v[104:107]
K1_XT10_4:
    s_waitcnt lgkmcnt(8)
    ds_read_b64_tr_b16 v[200:201], v216 offset:8192
    ds_read_b64_tr_b16 v[202:203], v216 offset:10240
    v_mfma_f32_16x16x32_bf16 v[72:75], v[180:183], v[168:171], v[72:75]
    v_mfma_f32_16x16x32_bf16 v[76:79], v[180:183], v[172:175], v[76:79]
    s_waitcnt lgkmcnt(8)
    v_add_u32 v215, s32, v215
    ds_read_b64_tr_b16 v[180:181], v215 offset:0
    ds_read_b64_tr_b16 v[182:183], v215 offset:2048
    v_mfma_f32_16x16x32_bf16 v[80:83], v[184:187], v[168:171], v[80:83]
    v_mfma_f32_16x16x32_bf16 v[84:87], v[184:187], v[172:175], v[84:87]
    s_cmp_eq_u32 s28, 0
    s_cbranch_scc0 K1_XT10_5
    v_mfma_f32_16x16x32_bf16 v[104:107], v[184:187], v[176:179], v[104:107]
K1_XT10_5:
    s_waitcnt lgkmcnt(8)
    v_add_u32 v216, s32, v216
    ds_read_b64_tr_b16 v[184:185], v216 offset:0
    ds_read_b64_tr_b16 v[186:187], v216 offset:2048
    v_mfma_f32_16x16x32_bf16 v[88:91], v[188:191], v[120:123], v[88:91]
    v_mfma_f32_16x16x32_bf16 v[92:95], v[188:191], v[124:127], v[92:95]
    s_cmp_eq_u32 s28, 1
    s_cbranch_scc0 K1_XT11_1
    v_mfma_f32_16x16x32_bf16 v[104:107], v[188:191], v[128:131], v[104:107]
K1_XT11_1:
    s_waitcnt lgkmcnt(8)
    ds_read_b64_tr_b16 v[188:189], v215 offset:4096
    ds_read_b64_tr_b16 v[190:191], v215 offset:6144
    v_mfma_f32_16x16x32_bf16 v[96:99], v[192:195], v[120:123], v[96:99]
    v_mfma_f32_16x16x32_bf16 v[100:103], v[192:195], v[124:127], v[100:103]
    s_cmp_eq_u32 s28, 2
    s_cbranch_scc0 K1_XT12_1
    v_mfma_f32_16x16x32_bf16 v[104:107], v[192:195], v[128:131], v[104:107]
K1_XT12_1:
    s_waitcnt lgkmcnt(8)
    ds_read_b64_tr_b16 v[192:193], v216 offset:4096
    ds_read_b64_tr_b16 v[194:195], v216 offset:6144
    v_mfma_f32_16x16x32_bf16 v[88:91], v[196:199], v[132:135], v[88:91]
    v_mfma_f32_16x16x32_bf16 v[92:95], v[196:199], v[136:139], v[92:95]
    s_cmp_eq_u32 s28, 1
    s_cbranch_scc0 K1_XT11_2
    v_mfma_f32_16x16x32_bf16 v[104:107], v[196:199], v[140:143], v[104:107]
K1_XT11_2:
    s_waitcnt lgkmcnt(8)
    ds_read_b64_tr_b16 v[196:197], v215 offset:8192
    ds_read_b64_tr_b16 v[198:199], v215 offset:10240
    v_mfma_f32_16x16x32_bf16 v[96:99], v[200:203], v[132:135], v[96:99]
    v_mfma_f32_16x16x32_bf16 v[100:103], v[200:203], v[136:139], v[100:103]
    s_cmp_eq_u32 s28, 2
    s_cbranch_scc0 K1_XT12_2
    v_mfma_f32_16x16x32_bf16 v[104:107], v[200:203], v[140:143], v[104:107]
K1_XT12_2:
    s_waitcnt lgkmcnt(8)
    ds_read_b64_tr_b16 v[200:201], v216 offset:8192
    ds_read_b64_tr_b16 v[202:203], v216 offset:10240
    v_mfma_f32_16x16x32_bf16 v[88:91], v[180:183], v[144:147], v[88:91]
    v_mfma_f32_16x16x32_bf16 v[92:95], v[180:183], v[148:151], v[92:95]
    s_cmp_eq_u32 s28, 1
    s_cbranch_scc0 K1_XT11_3
    v_mfma_f32_16x16x32_bf16 v[104:107], v[180:183], v[152:155], v[104:107]
K1_XT11_3:
    s_waitcnt lgkmcnt(8)
    v_mfma_f32_16x16x32_bf16 v[96:99], v[184:187], v[144:147], v[96:99]
    v_mfma_f32_16x16x32_bf16 v[100:103], v[184:187], v[148:151], v[100:103]
    s_cmp_eq_u32 s28, 2
    s_cbranch_scc0 K1_XT12_3
    v_mfma_f32_16x16x32_bf16 v[104:107], v[184:187], v[152:155], v[104:107]
K1_XT12_3:
    s_waitcnt lgkmcnt(6)
    v_mfma_f32_16x16x32_bf16 v[88:91], v[188:191], v[156:159], v[88:91]
    v_mfma_f32_16x16x32_bf16 v[92:95], v[188:191], v[160:163], v[92:95]
    s_cmp_eq_u32 s28, 1
    s_cbranch_scc0 K1_XT11_4
    v_mfma_f32_16x16x32_bf16 v[104:107], v[188:191], v[164:167], v[104:107]
K1_XT11_4:
    s_waitcnt lgkmcnt(4)
    v_mfma_f32_16x16x32_bf16 v[96:99], v[192:195], v[156:159], v[96:99]
    v_mfma_f32_16x16x32_bf16 v[100:103], v[192:195], v[160:163], v[100:103]
    s_cmp_eq_u32 s28, 2
    s_cbranch_scc0 K1_XT12_4
    v_mfma_f32_16x16x32_bf16 v[104:107], v[192:195], v[164:167], v[104:107]
K1_XT12_4:
    s_waitcnt lgkmcnt(2)
    v_mfma_f32_16x16x32_bf16 v[88:91], v[196:199], v[168:171], v[88:91]
    v_mfma_f32_16x16x32_bf16 v[92:95], v[196:199], v[172:175], v[92:95]
    s_cmp_eq_u32 s28, 1
    s_cbranch_scc0 K1_XT11_5
    v_mfma_f32_16x16x32_bf16 v[104:107], v[196:199], v[176:179], v[104:107]
K1_XT11_5:
    s_waitcnt lgkmcnt(0)
    v_mfma_f32_16x16x32_bf16 v[96:99], v[200:203], v[168:171], v[96:99]
    v_mfma_f32_16x16x32_bf16 v[100:103], v[200:203], v[172:175], v[100:103]
    s_cmp_eq_u32 s28, 2
    s_cbranch_scc0 K1_XT12_5
    v_mfma_f32_16x16x32_bf16 v[104:107], v[200:203], v[176:179], v[104:107]
K1_XT12_5:
    s_nop 7
    s_nop 7
    s_waitcnt vmcnt(13)
    s_barrier
    s_lshl_b32 s44, s28, 5
    v_add_u32 v241, s44, v228
    v_mul_u32_u24 v241, 80, v241
    v_lshl_add_u32 v240, v227, 4, v241
    v_mul_u32_u24 v242, 43520, v227
    v_add_u32 v242, v242, v241
    ds_write_b128 v240, v[72:75] offset:0
    ds_write_b128 v240, v[80:83] offset:21760
    ds_write_b128 v240, v[88:91] offset:43520
    s_mov_b32 exec_hi, 0
    ds_write_b64 v242, v[96:97] offset:64
    s_mov_b32 exec_lo, 0xffff
    ds_write_b64 v241, v[98:99] offset:21824
    s_mov_b64 exec, -1
    ds_write_b128 v240, v[76:79] offset:1280
    ds_write_b128 v240, v[84:87] offset:23040
    ds_write_b128 v240, v[92:95] offset:44800
    s_mov_b32 exec_hi, 0
    ds_write_b64 v242, v[100:101] offset:1344
    s_mov_b32 exec_lo, 0xffff
    ds_write_b64 v241, v[102:103] offset:23104
    s_mov_b64 exec, -1
    v_mul_u32_u24 v241, 80, v228
    v_lshl_add_u32 v242, v227, 4, v241
    s_cmp_gt_u32 s28, 1
    s_cbranch_scc1 K1_H2
    s_mul_i32 s44, s28, 21760
    v_add_u32 v242, s44, v242
    ds_write_b128 v242, v[104:107] offset:20480
    s_branch K1_HD
K1_H2:
    s_cmp_eq_u32 s28, 2
    s_cbranch_scc0 K1_HD
    s_mov_b64 exec, 0xffff
    ds_write_b64 v241, v[106:107] offset:20544
    s_mov_b32 exec_lo, 0xffff0000
    ds_write_b64 v241, v[104:105] offset:42304
    s_mov_b64 exec, -1
K1_HD:
    s_waitcnt lgkmcnt(0)
    s_barrier
    v_lshrrev_b32 v247, 5, v229
    v_lshl_add_u32 v246, v247, 4, v228
    v_and_b32 v232, 1, v227
    v_mul_u32_u24 v233, 80, v246
    v_lshl_add_u32 v244, v232, 5, v233
    v_lshl_add_u32 v245, v232, 2, v233
    ds_read_b128 v[0:3], v244 offset:0
    ds_read_b128 v[4:7], v244 offset:16
    ds_read_b32 v8, v245 offset:64
    ds_read_b128 v[12:15], v244 offset:21760
    ds_read_b128 v[16:19], v244 offset:21776
    ds_read_b32 v20, v245 offset:21824
    ds_read_b128 v[24:27], v244 offset:21600
    ds_read_b128 v[28:31], v244 offset:21616
    ds_read_b32 v32, v245 offset:21664
    ds_read_b128 v[36:39], v244 offset:21440
    ds_read_b128 v[40:43], v244 offset:21456
    ds_read_b32 v44, v245 offset:21504
    ds_read_b128 v[48:51], v244 offset:21280
    ds_read_b128 v[52:55], v244 offset:21296
    ds_read_b32 v56, v245 offset:21344
    s_add_u32 s20, s54, 0x2b62000
    s_addc_u32 s21, s55, 0
    s_mov_b32 s22, 0x4000
    s_mov_b32 s23, 0x00020000
    v_and_b32 v250, 7, v226
    v_lshlrev_b32 v250, 2, v250
    v_lshrrev_b32 v251, 3, v226
    v_lshl_add_u32 v250, v251, 5, v250
    v_mov_b32 v251, 1
    s_lshl_b32 s47, s30, 10
    s_lshl_b32 s48, s29, 5
    s_add_u32 s48, s48, s47
    s_lshl_b32 s49, s28, 2
    s_add_u32 s48, s48, s49
    s_add_u32 s49, s48, 8192
    s_waitcnt vmcnt(0)
    s_mov_b64 exec, 1
    buffer_store_dword v251, v250, s[20:23], s48 offen offset:0 sc1
    s_mov_b64 exec, -1
    s_and_b32 s51, s2, 7
    s_bfe_u32 s46, s2, 0x20003
    s_mul_i32 s40, s28, 12
    s_mul_i32 s41, s46, 288
    s_and_b32 s42, s46, 1
    s_lshl_b32 s43, s42, 5
    s_add_u32 s43, s43, s41
    s_xor_b32 s42, s42, 1
    s_lshl_b32 s42, s42, 8
    s_add_u32 s42, s42, s41
    s_mov_b32 s41, 1152
    v_lshrrev_b32 v200, 4, v226
    v_add3_u32 v200, v200, s40, 0
    v_bfe_u32 v201, v226, 1, 3
    v_xor_b32 v201, v201, v200
    v_and_b32 v201, 7, v201
    v_and_b32 v202, 0x63, v200
    v_bfe_u32 v203, v200, 2, 2
    v_lshl_add_u32 v202, v203, 3, v202
    v_bfe_u32 v203, v200, 4, 1
    v_lshl_add_u32 v202, v203, 2, v202
    v_mov_b32 v200, v202
    v_mul_lo_u32 v200, v200, s41
    v_lshl_add_u32 v200, v201, 5, v200
    v_and_b32 v201, 1, v226
    v_lshl_add_u32 v200, v201, 4, v200
    v_add_u32 v189, s43, v200
    s_sub_u32 s43, s43, 1024
    v_lshrrev_b32 v200, 4, v226
    v_add3_u32 v200, v200, s40, 4
    v_bfe_u32 v201, v226, 1, 3
    v_xor_b32 v201, v201, v200
    v_and_b32 v201, 7, v201
    v_and_b32 v202, 0x63, v200
    v_bfe_u32 v203, v200, 2, 2
    v_lshl_add_u32 v202, v203, 3, v202
    v_bfe_u32 v203, v200, 4, 1
    v_lshl_add_u32 v202, v203, 2, v202
    v_mov_b32 v200, v202
    v_mul_lo_u32 v200, v200, s41
    v_lshl_add_u32 v200, v201, 5, v200
    v_and_b32 v201, 1, v226
    v_lshl_add_u32 v200, v201, 4, v200
    v_add_u32 v190, s43, v200
    s_sub_u32 s43, s43, 1024
    v_lshrrev_b32 v200, 4, v226
    v_add3_u32 v200, v200, s40, 8
    v_bfe_u32 v201, v226, 1, 3
    v_xor_b32 v201, v201, v200
    v_and_b32 v201, 7, v201
    v_and_b32 v202, 0x63, v200
    v_bfe_u32 v203, v200, 2, 2
    v_lshl_add_u32 v202, v203, 3, v202
    v_bfe_u32 v203, v200, 4, 1
    v_lshl_add_u32 v202, v203, 2, v202
    v_mov_b32 v200, v202
    v_mul_lo_u32 v200, v200, s41
    v_lshl_add_u32 v200, v201, 5, v200
    v_and_b32 v201, 1, v226
    v_lshl_add_u32 v200, v201, 4, v200
    v_add_u32 v191, s43, v200
    s_sub_u32 s43, s43, 1024
    v_lshrrev_b32 v200, 1, v226
    v_add_u32 v200, s40, v200
    v_and_b32 v202, 0x63, v200
    v_bfe_u32 v203, v200, 2, 2
    v_lshl_add_u32 v202, v203, 3, v202
    v_bfe_u32 v203, v200, 4, 1
    v_lshl_add_u32 v202, v203, 2, v202
    v_mov_b32 v200, v202
    v_mul_lo_u32 v200, v200, s41
    v_lshl_add_u32 v200, v201, 4, v200
    v_add_u32 v192, s42, v200
    s_mul_i32 s39, s28, 3072
    s_add_u32 s39, s39, 49152
    s_mul_i32 s45, s28, 384
    s_add_u32 s45, s45, 73728
    s_add_u32 s16, s54, 0x1962000
    s_addc_u32 s17, s55, 0
    s_mov_b32 s18, 0x1200000
    s_mov_b32 s19, 0x00020000
    s_cmp_eq_u32 s51, 7
    s_cbranch_scc1 K2_SJOB
    s_mov_b32 s8, s58
    s_mov_b32 s9, s59
    s_mov_b32 s10, 0x510000
    s_mov_b32 s11, 0x00020000
    s_mov_b32 s12, s54
    s_mov_b32 s13, s55
    s_mov_b32 s14, 0x1200000
    s_mov_b32 s15, 0x00020000
    s_mul_i32 s37, s51, 774144
    s_mul_i32 s36, s51, 2752512
    s_add_u32 s40, s37, 774144
    s_min_u32 s10, s40, s10
    s_branch K2_GO
K2_SJOB:
    s_add_u32 s8, s54, 0x18c0000
    s_addc_u32 s9, s55, 0
    s_mov_b32 s10, 0xa2000
    s_mov_b32 s11, 0x00020000
    s_add_u32 s12, s54, 0x1200000
    s_addc_u32 s13, s55, 0
    s_mov_b32 s14, 0x240000
    s_mov_b32 s15, 0x00020000
    s_mov_b32 s37, 0xfffe5000
    s_mov_b32 s36, 0
K2_GO:
    s_mov_b32 s34, 27648
    s_mov_b32 s33, 27648
    s_mov_b32 s32, 76800
    s_add_u32 m0, s34, s39
    s_nop 0
    buffer_load_dwordx4 v189, s[8:11], s37 offen offset:0 lds
    s_add_u32 m0, s34, s45
    s_mov_b32 exec_lo, 0xffffff
    s_mov_b32 exec_hi, 0
    buffer_load_dwordx4 v192, s[8:11], s37 offen offset:0 lds
    s_mov_b64 exec, -1
    s_add_u32 m0, s34, s39
    s_nop 0
    buffer_load_dwordx4 v190, s[8:11], s37 offen offset:1024 lds
    s_add_u32 m0, s34, s39
    s_nop 0
    buffer_load_dwordx4 v191, s[8:11], s37 offen offset:2048 lds
    s_add_u32 s37, s37, 110592
    s_add_u32 s34, s34, 27648
    s_cmp_ge_u32 s34, 110592
    s_cselect_b32 s34, 0, s34
    s_add_u32 m0, s34, s39
    s_nop 0
    buffer_load_dwordx4 v189, s[8:11], s37 offen offset:0 lds
    s_add_u32 m0, s34, s45
    s_mov_b32 exec_lo, 0xffffff
    s_mov_b32 exec_hi, 0
    buffer_load_dwordx4 v192, s[8:11], s37 offen offset:0 lds
    s_mov_b64 exec, -1
    s_add_u32 m0, s34, s39
    s_nop 0
    buffer_load_dwordx4 v190, s[8:11], s37 offen offset:1024 lds
    s_add_u32 m0, s34, s39
    s_nop 0
    buffer_load_dwordx4 v191, s[8:11], s37 offen offset:2048 lds
    s_add_u32 s37, s37, 110592
    s_add_u32 s34, s34, 27648
    s_cmp_ge_u32 s34, 110592
    s_cselect_b32 s34, 0, s34
    s_add_u32 m0, s34, s39
    s_nop 0
    buffer_load_dwordx4 v189, s[8:11], s37 offen offset:0 lds
    s_add_u32 m0, s34, s45
    s_mov_b32 exec_lo, 0xffffff
    s_mov_b32 exec_hi, 0
    buffer_load_dwordx4 v192, s[8:11], s37 offen offset:0 lds
    s_mov_b64 exec, -1
    s_add_u32 m0, s34, s39
    s_nop 0
    buffer_load_dwordx4 v190, s[8:11], s37 offen offset:1024 lds
    s_add_u32 m0, s34, s39
    s_nop 0
    buffer_load_dwordx4 v191, s[8:11], s37 offen offset:2048 lds
    s_add_u32 s37, s37, 110592
    s_add_u32 s34, s34, 27648
    s_cmp_ge_u32 s34, 110592
    s_cselect_b32 s34, 0, s34
    v_lshrrev_b32 v200, 2, v226
    v_and_b32 v201, 3, v226
    v_and_b32 v202, 7, v200
    v_lshlrev_b32 v203, 8, v200
    v_lshl_add_u32 v203, v202, 5, v203
    v_lshl_add_u32 v180, v201, 3, v203
    v_xor_b32 v181, 32, v180
    v_xor_b32 v182, 64, v180
    v_xor_b32 v183, 96, v180
    v_xor_b32 v184, 128, v180
    v_xor_b32 v185, 160, v180
    v_xor_b32 v186, 192, v180
    v_xor_b32 v187, 224, v180
    v_lshlrev_b32 v188, 3, v226
    v_add_u32 v188, 24576, v188
    s_lshl_b32 s40, s30, 4
    s_lshl_b32 s41, s28, 1
    s_add_u32 s41, s41, s40
    s_lshl_b32 s41, s41, 10
    v_lshlrev_b32 v200, 4, v226
    v_add_u32 v193, s41, v200
    s_mov_b32 s50, s2
    s_mul_i32 s40, s51, 14
    s_add_u32 s41, s40, 16
    s_mul_i32 s40, s40, 21846
    s_lshr_b32 s40, s40, 16
    s_mul_i32 s41, s41, 21846
    s_lshr_b32 s41, s41, 16
    s_min_u32 s41, s41, 32
    s_sub_u32 s41, s41, s40
    s_lshl_b32 s41, s41, 3
    s_bfm_b64 s[2:3], s41, 0
    s_lshl_b32 s40, s40, 5
    s_cmp_eq_u32 s51, 7
    s_cselect_b32 s40, 8192, s40
    s_cselect_b64 s[2:3], -1, s[2:3]
    s_add_u32 s47, s47, s40
    s_lshl_b32 s40, s30, 8
    v_add_u32 v246, s40, v246
    s_mov_b32 s41, 0x3eae1a93
    v_mov_b32 v234, 0xceabfb8f
    s_waitcnt lgkmcnt(9)
    v_mul_f32 v112, v0, v12
    v_fmac_f32 v112, v1, v13
    v_fmac_f32 v112, v2, v14
    v_fmac_f32 v112, v3, v15
    v_fmac_f32 v112, v4, v16
    v_fmac_f32 v112, v5, v17
    v_fmac_f32 v112, v6, v18
    v_fmac_f32 v112, v7, v19
    v_fmac_f32 v112, v8, v20
    ds_read_b128 v[60:63], v244 offset:21120
    ds_read_b128 v[64:67], v244 offset:21136
    ds_read_b32 v68, v245 offset:21184
    s_waitcnt lgkmcnt(9)
    v_mul_f32 v113, v0, v24
    v_fmac_f32 v113, v1, v25
    v_fmac_f32 v113, v2, v26
    v_fmac_f32 v113, v3, v27
    v_fmac_f32 v113, v4, v28
    v_fmac_f32 v113, v5, v29
    v_fmac_f32 v113, v6, v30
    v_fmac_f32 v113, v7, v31
    v_fmac_f32 v113, v8, v32
    ds_read_b128 v[72:75], v244 offset:20960
    ds_read_b128 v[76:79], v244 offset:20976
    ds_read_b32 v80, v245 offset:21024
    s_waitcnt lgkmcnt(9)
    v_mul_f32 v114, v0, v36
    v_fmac_f32 v114, v1, v37
    v_fmac_f32 v114, v2, v38
    v_fmac_f32 v114, v3, v39
    v_fmac_f32 v114, v4, v40
    v_fmac_f32 v114, v5, v41
    v_fmac_f32 v114, v6, v42
    v_fmac_f32 v114, v7, v43
    v_fmac_f32 v114, v8, v44
    ds_read_b128 v[84:87], v244 offset:20800
    ds_read_b128 v[88:91], v244 offset:20816
    ds_read_b32 v92, v245 offset:20864
    s_waitcnt lgkmcnt(9)
    v_mul_f32 v115, v0, v48
    v_fmac_f32 v115, v1, v49
    v_fmac_f32 v115, v2, v50
    v_fmac_f32 v115, v3, v51
    v_fmac_f32 v115, v4, v52
    v_fmac_f32 v115, v5, v53
    v_fmac_f32 v115, v6, v54
    v_fmac_f32 v115, v7, v55
    v_fmac_f32 v115, v8, v56
    ds_read_b128 v[96:99], v244 offset:20640
    ds_read_b128 v[100:103], v244 offset:20656
    ds_read_b32 v104, v245 offset:20704
    s_waitcnt lgkmcnt(9)
    v_mul_f32 v116, v0, v60
    v_fmac_f32 v116, v1, v61
    v_fmac_f32 v116, v2, v62
    v_fmac_f32 v116, v3, v63
    v_fmac_f32 v116, v4, v64
    v_fmac_f32 v116, v5, v65
    v_fmac_f32 v116, v6, v66
    v_fmac_f32 v116, v7, v67
    v_fmac_f32 v116, v8, v68
    s_waitcnt lgkmcnt(6)
    v_mul_f32 v117, v0, v72
    v_fmac_f32 v117, v1, v73
    v_fmac_f32 v117, v2, v74
    v_fmac_f32 v117, v3, v75
    v_fmac_f32 v117, v4, v76
    v_fmac_f32 v117, v5, v77
    v_fmac_f32 v117, v6, v78
    v_fmac_f32 v117, v7, v79
    v_fmac_f32 v117, v8, v80
    s_waitcnt lgkmcnt(3)
    v_mul_f32 v118, v0, v84
    v_fmac_f32 v118, v1, v85
    v_fmac_f32 v118, v2, v86
    v_fmac_f32 v118, v3, v87
    v_fmac_f32 v118, v4, v88
    v_fmac_f32 v118, v5, v89
    v_fmac_f32 v118, v6, v90
    v_fmac_f32 v118, v7, v91
    v_fmac_f32 v118, v8, v92
    s_waitcnt lgkmcnt(0)
    v_mul_f32 v119, v0, v96
    v_fmac_f32 v119, v1, v97
    v_fmac_f32 v119, v2, v98
    v_fmac_f32 v119, v3, v99
    v_fmac_f32 v119, v4, v100
    v_fmac_f32 v119, v5, v101
    v_fmac_f32 v119, v6, v102
    v_fmac_f32 v119, v7, v103
    v_fmac_f32 v119, v8, v104
    ds_read_b128 v[12:15], v244 offset:43520
    ds_read_b128 v[16:19], v244 offset:43536
    ds_read_b32 v20, v245 offset:43584
    ds_read_b128 v[24:27], v244 offset:43360
    ds_read_b128 v[28:31], v244 offset:43376
    ds_read_b32 v32, v245 offset:43424
    ds_read_b128 v[36:39], v244 offset:43200
    ds_read_b128 v[40:43], v244 offset:43216
    ds_read_b32 v44, v245 offset:43264
    ds_read_b128 v[48:51], v244 offset:43040
    ds_read_b128 v[52:55], v244 offset:43056
    ds_read_b32 v56, v245 offset:43104
    ds_read_b128 v[60:63], v244 offset:42880
    ds_read_b128 v[64:67], v244 offset:42896
    ds_read_b32 v68, v245 offset:42944
    v_mov_b32 v124, v112
    v_mov_b32 v125, v113
    v_mov_b32 v126, v114
    v_mov_b32 v127, v115
    v_mov_b32 v128, v116
    v_mov_b32 v129, v117
    v_mov_b32 v130, v118
    v_mov_b32 v131, v119
    s_nop 1
    v_permlane16_swap_b32 v112, v124
    v_permlane16_swap_b32 v113, v125
    v_permlane16_swap_b32 v114, v126
    v_permlane16_swap_b32 v115, v127
    v_permlane16_swap_b32 v116, v128
    v_permlane16_swap_b32 v117, v129
    v_permlane16_swap_b32 v118, v130
    v_permlane16_swap_b32 v119, v131
    s_nop 1
    v_add_f32 v112, v112, v124
    v_cmp_le_u32 vcc, 0, v246
    v_mul_f32 v112, s41, v112
    s_nop 0
    v_cndmask_b32 v112, v234, v112, vcc
    v_add_f32 v113, v113, v125
    v_cmp_le_u32 vcc, 2, v246
    v_mul_f32 v113, s41, v113
    s_nop 0
    v_cndmask_b32 v113, v234, v113, vcc
    v_add_f32 v114, v114, v126
    v_cmp_le_u32 vcc, 4, v246
    v_mul_f32 v114, s41, v114
    s_nop 0
    v_cndmask_b32 v114, v234, v114, vcc
    v_add_f32 v115, v115, v127
    v_cmp_le_u32 vcc, 6, v246
    v_mul_f32 v115, s41, v115
    s_nop 0
    v_cndmask_b32 v115, v234, v115, vcc
    v_add_f32 v116, v116, v128
    v_cmp_le_u32 vcc, 8, v246
    v_mul_f32 v116, s41, v116
    s_nop 0
    v_cndmask_b32 v116, v234, v116, vcc
    v_add_f32 v117, v117, v129
    v_cmp_le_u32 vcc, 10, v246
    v_mul_f32 v117, s41, v117
    s_nop 0
    v_cndmask_b32 v117, v234, v117, vcc
    v_add_f32 v118, v118, v130
    v_cmp_le_u32 vcc, 12, v246
    v_mul_f32 v118, s41, v118
    s_nop 0
    v_cndmask_b32 v118, v234, v118, vcc
    v_add_f32 v119, v119, v131
    v_cmp_le_u32 vcc, 14, v246
    v_mul_f32 v119, s41, v119
    s_nop 0
    v_cndmask_b32 v119, v234, v119, vcc
    v_max3_f32 v235, v112, v113, v114
    v_max3_f32 v235, v235, v115, v116
    v_max3_f32 v235, v235, v117, v118
    v_max_f32 v235, v235, v119
    v_sub_f32 v112, v112, v235
    v_exp_f32 v112, v112
    v_sub_f32 v113, v113, v235
    v_exp_f32 v113, v113
    v_sub_f32 v114, v114, v235
    v_exp_f32 v114, v114
    v_sub_f32 v115, v115, v235
    v_exp_f32 v115, v115
    v_sub_f32 v116, v116, v235
    v_exp_f32 v116, v116
    v_sub_f32 v117, v117, v235
    v_exp_f32 v117, v117
    v_sub_f32 v118, v118, v235
    v_exp_f32 v118, v118
    v_sub_f32 v119, v119, v235
    v_exp_f32 v119, v119
    s_nop 0
    v_add_f32 v236, v112, v113
    v_add_f32 v236, v236, v114
    v_add_f32 v236, v236, v115
    v_add_f32 v236, v236, v116
    v_add_f32 v236, v236, v117
    v_add_f32 v236, v236, v118
    v_add_f32 v236, v236, v119
    v_rcp_f32 v236, v236
    s_waitcnt lgkmcnt(12)
    v_mul_f32 v124, v112, v12
    v_mul_f32 v125, v112, v13
    v_mul_f32 v126, v112, v14
    v_mul_f32 v127, v112, v15
    v_mul_f32 v128, v112, v16
    v_mul_f32 v129, v112, v17
    v_mul_f32 v130, v112, v18
    v_mul_f32 v131, v112, v19
    v_mul_f32 v132, v112, v20
    ds_read_b128 v[72:75], v244 offset:42720
    ds_read_b128 v[76:79], v244 offset:42736
    ds_read_b32 v80, v245 offset:42784
    s_waitcnt lgkmcnt(12)
    v_fmac_f32 v124, v113, v24
    v_fmac_f32 v125, v113, v25
    v_fmac_f32 v126, v113, v26
    v_fmac_f32 v127, v113, v27
    v_fmac_f32 v128, v113, v28
    v_fmac_f32 v129, v113, v29
    v_fmac_f32 v130, v113, v30
    v_fmac_f32 v131, v113, v31
    v_fmac_f32 v132, v113, v32
    ds_read_b128 v[84:87], v244 offset:42560
    ds_read_b128 v[88:91], v244 offset:42576
    ds_read_b32 v92, v245 offset:42624
    s_waitcnt lgkmcnt(12)
    v_fmac_f32 v124, v114, v36
    v_fmac_f32 v125, v114, v37
    v_fmac_f32 v126, v114, v38
    v_fmac_f32 v127, v114, v39
    v_fmac_f32 v128, v114, v40
    v_fmac_f32 v129, v114, v41
    v_fmac_f32 v130, v114, v42
    v_fmac_f32 v131, v114, v43
    v_fmac_f32 v132, v114, v44
    ds_read_b128 v[96:99], v244 offset:42400
    ds_read_b128 v[100:103], v244 offset:42416
    ds_read_b32 v104, v245 offset:42464
    s_waitcnt lgkmcnt(12)
    v_fmac_f32 v124, v115, v48
    v_fmac_f32 v125, v115, v49
    v_fmac_f32 v126, v115, v50
    v_fmac_f32 v127, v115, v51
    v_fmac_f32 v128, v115, v52
    v_fmac_f32 v129, v115, v53
    v_fmac_f32 v130, v115, v54
    v_fmac_f32 v131, v115, v55
    v_fmac_f32 v132, v115, v56
    s_waitcnt lgkmcnt(9)
    v_fmac_f32 v124, v116, v60
    v_fmac_f32 v125, v116, v61
    v_fmac_f32 v126, v116, v62
    v_fmac_f32 v127, v116, v63
    v_fmac_f32 v128, v116, v64
    v_fmac_f32 v129, v116, v65
    v_fmac_f32 v130, v116, v66
    v_fmac_f32 v131, v116, v67
    v_fmac_f32 v132, v116, v68
    s_waitcnt lgkmcnt(6)
    v_fmac_f32 v124, v117, v72
    v_fmac_f32 v125, v117, v73
    v_fmac_f32 v126, v117, v74
    v_fmac_f32 v127, v117, v75
    v_fmac_f32 v128, v117, v76
    v_fmac_f32 v129, v117, v77
    v_fmac_f32 v130, v117, v78
    v_fmac_f32 v131, v117, v79
    v_fmac_f32 v132, v117, v80
    s_waitcnt lgkmcnt(3)
    v_fmac_f32 v124, v118, v84
    v_fmac_f32 v125, v118, v85
    v_fmac_f32 v126, v118, v86
    v_fmac_f32 v127, v118, v87
    v_fmac_f32 v128, v118, v88
    v_fmac_f32 v129, v118, v89
    v_fmac_f32 v130, v118, v90
    v_fmac_f32 v131, v118, v91
    v_fmac_f32 v132, v118, v92
    s_waitcnt lgkmcnt(0)
    v_fmac_f32 v124, v119, v96
    v_fmac_f32 v125, v119, v97
    v_fmac_f32 v126, v119, v98
    v_fmac_f32 v127, v119, v99
    v_fmac_f32 v128, v119, v100
    v_fmac_f32 v129, v119, v101
    v_fmac_f32 v130, v119, v102
    v_fmac_f32 v131, v119, v103
    v_fmac_f32 v132, v119, v104
    v_mul_f32 v124, v236, v124
    v_mul_f32 v125, v236, v125
    v_mul_f32 v126, v236, v126
    v_mul_f32 v127, v236, v127
    v_mul_f32 v128, v236, v128
    v_mul_f32 v129, v236, v129
    v_mul_f32 v130, v236, v130
    v_mul_f32 v131, v236, v131
    v_mul_f32 v132, v236, v132
    v_cvt_pk_bf16_f32 v0, v124, v125
    v_cvt_pk_bf16_f32 v1, v126, v127
    v_cvt_pk_bf16_f32 v2, v128, v129
    v_cvt_pk_bf16_f32 v3, v130, v131
    v_mov_b32 v133, v132
    s_nop 1
    v_permlane16_swap_b32 v132, v133
    s_nop 1
    v_cvt_pk_bf16_f32 v4, v132, v133
    s_lshl_b32 s40, s30, 4
    v_add_u32 v237, s40, v247
    v_lshlrev_b32 v237, 10, v237
    v_lshl_add_u32 v237, v228, 4, v237
    v_lshl_add_u32 v238, v232, 8, v237
    s_lshr_b32 s42, s29, 1
    s_lshl_b32 s42, s42, 17
    s_and_b32 s41, s29, 1
    s_lshl_b32 s41, s41, 9
    s_add_u32 s42, s42, s41
    s_bfe_u32 s43, s29, 0x20002
    s_lshl_b32 s43, s43, 8
    s_and_b32 s41, s29, 3
    s_lshl_b32 s41, s41, 2
    s_add_u32 s43, s43, s41
    s_lshr_b32 s41, s29, 4
    s_add_u32 s41, s41, 16
    s_lshl_b32 s41, s41, 17
    s_add_u32 s43, s43, s41
    buffer_store_dwordx4 v[0:3], v238, s[24:27], s42 offen sc1
    s_mov_b32 exec_lo, 0xffff
    s_mov_b32 exec_hi, 0xffff
    buffer_store_dword v4, v237, s[24:27], s43 offen sc1
    s_mov_b64 exec, -1
    v_and_b32 v249, 1, v226
    v_lshlrev_b32 v249, 4, v249
    v_lshrrev_b32 v248, 1, v226
    v_lshl_add_u32 v249, v248, 5, v249
    s_cmp_lg_u32 s28, 7
    s_cbranch_scc1 K1_NPL
    s_cmp_eq_u32 s51, 7
    s_cbranch_scc1 K1_NPL
    s_mov_b32 s42, 0
    buffer_load_dword v244, v250, s[20:23], s47 offen sc1
    s_waitcnt vmcnt(1)
    s_mov_b64 exec, 1
    buffer_store_dword v251, v250, s[20:23], s49 offen offset:0 sc1
    s_mov_b64 exec, -1
    v_mov_b32 v240, 0
K1_PH:
    s_waitcnt vmcnt(1)
    v_cmp_eq_u32 vcc, 1, v244
    s_nop 3
    s_and_b64 s[40:41], vcc, s[2:3]
    s_cmp_eq_u64 s[40:41], s[2:3]
    s_cbranch_scc1 K1_PHX
    s_sleep 8
    buffer_load_dword v240, v250, s[20:23], s47 offen sc1
    s_waitcnt vmcnt(0)
    s_waitcnt vmcnt(1)
    v_cmp_eq_u32 vcc, 1, v240
    s_nop 3
    s_and_b64 s[40:41], vcc, s[2:3]
    s_cmp_eq_u64 s[40:41], s[2:3]
    s_cbranch_scc1 K1_PHX
    s_sleep 8
    buffer_load_dword v236, v250, s[20:23], s47 offen sc1
    s_waitcnt vmcnt(0)
    s_waitcnt vmcnt(1)
    v_cmp_eq_u32 vcc, 1, v236
    s_nop 3
    s_and_b64 s[40:41], vcc, s[2:3]
    s_cmp_eq_u64 s[40:41], s[2:3]
    s_cbranch_scc1 K1_PHX
    s_sleep 8
    buffer_load_dword v244, v250, s[20:23], s47 offen sc1
    s_waitcnt vmcnt(0)
    s_add_u32 s42, s42, 1
    s_cmp_lt_u32 s42, 20000
    s_cbranch_scc1 K1_PH
K1_PHX:
    s_branch K1_POX
K1_NPL:
    s_waitcnt vmcnt(0)
    s_mov_b64 exec, 1
    buffer_store_dword v251, v250, s[20:23], s49 offen offset:0 sc1
    s_mov_b64 exec, -1
    s_cmp_lg_u32 s28, 7
    s_cbranch_scc1 K1_POX
    s_mov_b32 s42, 0
    buffer_load_dwordx4 v[244:247], v249, s[20:23], s47 offen sc1
K1_PO:
    s_waitcnt vmcnt(0)
    v_min_u32 v244, v244, v245
    v_min3_u32 v244, v244, v246, v247
    v_cmp_eq_u32 vcc, 1, v244
    s_nop 3
    s_and_b64 s[40:41], vcc, s[2:3]
    s_cmp_eq_u64 s[40:41], s[2:3]
    s_cbranch_scc1 K1_POX
    s_sleep 8
    buffer_load_dwordx4 v[240:243], v249, s[20:23], s47 offen sc1
    s_waitcnt vmcnt(0)
    v_min_u32 v240, v240, v241
    v_min3_u32 v240, v240, v242, v243
    v_cmp_eq_u32 vcc, 1, v240
    s_nop 3
    s_and_b64 s[40:41], vcc, s[2:3]
    s_cmp_eq_u64 s[40:41], s[2:3]
    s_cbranch_scc1 K1_POX
    s_sleep 8
    buffer_load_dwordx4 v[236:239], v249, s[20:23], s47 offen sc1
    s_waitcnt vmcnt(0)
    v_min_u32 v236, v236, v237
    v_min3_u32 v236, v236, v238, v239
    v_cmp_eq_u32 vcc, 1, v236
    s_nop 3
    s_and_b64 s[40:41], vcc, s[2:3]
    s_cmp_eq_u64 s[40:41], s[2:3]
    s_cbranch_scc1 K1_POX
    s_sleep 8
    buffer_load_dwordx4 v[244:247], v249, s[20:23], s47 offen sc1
    s_add_u32 s42, s42, 1
    s_cmp_lt_u32 s42, 20000
    s_cbranch_scc1 K1_PO
K1_POX:
    s_mov_b32 s2, s50
    s_barrier
    s_cmp_lg_u32 s51, 7
    s_cbranch_scc1 K2_FULL
    buffer_load_dwordx4 v[96:99], v193, s[12:15], s36 offen offset:0 sc1
    buffer_load_dwordx4 v[100:103], v193, s[12:15], s36 offen offset:1024 sc1
    s_add_u32 s36, s36, 0x20000
    buffer_load_dwordx4 v[104:107], v193, s[12:15], s36 offen offset:0 sc1
    buffer_load_dwordx4 v[108:111], v193, s[12:15], s36 offen offset:1024 sc1
    s_add_u32 s36, s36, 0x20000
    buffer_load_dwordx4 v[112:115], v193, s[12:15], s36 offen offset:0 sc1
    buffer_load_dwordx4 v[116:119], v193, s[12:15], s36 offen offset:1024 sc1
    s_add_u32 s36, s36, 0x20000
    buffer_load_dwordx4 v[72:75], v193, s[12:15], s36 offen offset:0 sc1
    buffer_load_dwordx4 v[76:79], v193, s[12:15], s36 offen offset:1024 sc1
    s_add_u32 s36, s36, 0x20000
    buffer_load_dwordx4 v[80:83], v193, s[12:15], s36 offen offset:0 sc1
    buffer_load_dwordx4 v[84:87], v193, s[12:15], s36 offen offset:1024 sc1
    s_add_u32 s36, s36, 0x20000
    s_add_u32 m0, s34, s39
    s_nop 0
    buffer_load_dwordx4 v189, s[8:11], s37 offen offset:0 lds
    s_add_u32 m0, s34, s45
    s_mov_b32 exec_lo, 0xffffff
    s_mov_b32 exec_hi, 0
    buffer_load_dwordx4 v192, s[8:11], s37 offen offset:0 lds
    s_mov_b64 exec, -1
    s_add_u32 m0, s34, s39
    s_nop 0
    buffer_load_dwordx4 v190, s[8:11], s37 offen offset:1024 lds
    s_add_u32 m0, s34, s39
    s_nop 0
    buffer_load_dwordx4 v191, s[8:11], s37 offen offset:2048 lds
    s_add_u32 s37, s37, 110592
    s_add_u32 s34, s34, 27648
    s_cmp_ge_u32 s34, 110592
    s_cselect_b32 s34, 0, s34
    v_add_u32 v180, s32, v180
    v_add_u32 v181, s32, v181
    v_add_u32 v182, s32, v182
    v_add_u32 v183, s32, v183
    v_add_u32 v184, s32, v184
    v_add_u32 v185, s32, v185
    v_add_u32 v186, s32, v186
    v_add_u32 v187, s32, v187
    v_add_u32 v188, s32, v188
    s_add_u32 s33, s33, 27648
    s_cmp_ge_u32 s33, 110592
    s_cselect_b32 s32, 110592, 0
    s_sub_u32 s33, s33, s32
    s_sub_u32 s32, 27648, s32
    v_add_u32 v180, s32, v180
    ds_read_b64_tr_b16 v[144:145], v180 offset:0
    ds_read_b64_tr_b16 v[146:147], v180 offset:4096
    v_add_u32 v181, s32, v181
    ds_read_b64_tr_b16 v[148:149], v181 offset:0
    ds_read_b64_tr_b16 v[150:151], v181 offset:4096
    v_add_u32 v182, s32, v182
    ds_read_b64_tr_b16 v[152:153], v182 offset:0
    ds_read_b64_tr_b16 v[154:155], v182 offset:4096
    v_add_u32 v183, s32, v183
    ds_read_b64_tr_b16 v[156:157], v183 offset:0
    ds_read_b64_tr_b16 v[158:159], v183 offset:4096
    v_add_u32 v184, s32, v184
    ds_read_b64_tr_b16 v[160:161], v184 offset:0
    ds_read_b64_tr_b16 v[162:163], v184 offset:4096
    v_add_u32 v185, s32, v185
    ds_read_b64_tr_b16 v[164:165], v185 offset:0
    ds_read_b64_tr_b16 v[166:167], v185 offset:4096
    v_mov_b32 v0, 0
    v_mov_b32 v1, 0
    v_mov_b32 v2, 0
    v_mov_b32 v3, 0
    v_mov_b32 v4, 0
    v_mov_b32 v5, 0
    v_mov_b32 v6, 0
    v_mov_b32 v7, 0
    v_mov_b32 v8, 0
    v_mov_b32 v9, 0
    v_mov_b32 v10, 0
    v_mov_b32 v11, 0
    v_mov_b32 v12, 0
    v_mov_b32 v13, 0
    v_mov_b32 v14, 0
    v_mov_b32 v15, 0
    v_mov_b32 v16, 0
    v_mov_b32 v17, 0
    v_mov_b32 v18, 0
    v_mov_b32 v19, 0
    v_mov_b32 v20, 0
    v_mov_b32 v21, 0
    v_mov_b32 v22, 0
    v_mov_b32 v23, 0
    v_mov_b32 v24, 0
    v_mov_b32 v25, 0
    v_mov_b32 v26, 0
    v_mov_b32 v27, 0
    v_mov_b32 v28, 0
    v_mov_b32 v29, 0
    v_mov_b32 v30, 0
    v_mov_b32 v31, 0
    v_mov_b32 v32, 0
    v_mov_b32 v33, 0
    v_mov_b32 v34, 0
    v_mov_b32 v35, 0
    v_mov_b32 v36, 0
    v_mov_b32 v37, 0
    v_mov_b32 v38, 0
    v_mov_b32 v39, 0
    v_mov_b32 v40, 0
    v_mov_b32 v41, 0
    v_mov_b32 v42, 0
    v_mov_b32 v43, 0
    v_mov_b32 v44, 0
    v_mov_b32 v45, 0
    v_mov_b32 v46, 0
    v_mov_b32 v47, 0
    v_mov_b32 v48, 0
    v_mov_b32 v49, 0
    v_mov_b32 v50, 0
    v_mov_b32 v51, 0
    v_mov_b32 v52, 0
    v_mov_b32 v53, 0
    v_mov_b32 v54, 0
    v_mov_b32 v55, 0
    v_mov_b32 v56, 0
    v_mov_b32 v57, 0
    v_mov_b32 v58, 0
    v_mov_b32 v59, 0
    v_mov_b32 v60, 0
    v_mov_b32 v61, 0
    v_mov_b32 v62, 0
    v_mov_b32 v63, 0
    v_mov_b32 v64, 0
    v_mov_b32 v65, 0
    v_mov_b32 v66, 0
    v_mov_b32 v67, 0
    v_mov_b32 v68, 0
    v_mov_b32 v69, 0
    v_mov_b32 v70, 0
    v_mov_b32 v71, 0
    s_branch K2_JOIN
K2_FULL:
    buffer_load_dwordx4 v[72:75], v193, s[12:15], s36 offen offset:0 sc1
    buffer_load_dwordx4 v[76:79], v193, s[12:15], s36 offen offset:1024 sc1
    s_add_u32 s36, s36, 0x20000
    buffer_load_dwordx4 v[80:83], v193, s[12:15], s36 offen offset:0 sc1
    buffer_load_dwordx4 v[84:87], v193, s[12:15], s36 offen offset:1024 sc1
    s_add_u32 s36, s36, 0x20000
    buffer_load_dwordx4 v[88:91], v193, s[12:15], s36 offen offset:0 sc1
    buffer_load_dwordx4 v[92:95], v193, s[12:15], s36 offen offset:1024 sc1
    s_add_u32 s36, s36, 0x20000
    v_add_u32 v180, s32, v180
    ds_read_b64_tr_b16 v[144:145], v180 offset:0
    ds_read_b64_tr_b16 v[146:147], v180 offset:4096
    v_add_u32 v181, s32, v181
    ds_read_b64_tr_b16 v[148:149], v181 offset:0
    ds_read_b64_tr_b16 v[150:151], v181 offset:4096
    v_add_u32 v182, s32, v182
    ds_read_b64_tr_b16 v[152:153], v182 offset:0
    ds_read_b64_tr_b16 v[154:155], v182 offset:4096
    v_add_u32 v183, s32, v183
    ds_read_b64_tr_b16 v[156:157], v183 offset:0
    ds_read_b64_tr_b16 v[158:159], v183 offset:4096
    v_add_u32 v184, s32, v184
    ds_read_b64_tr_b16 v[160:161], v184 offset:0
    ds_read_b64_tr_b16 v[162:163], v184 offset:4096
    v_add_u32 v185, s32, v185
    ds_read_b64_tr_b16 v[164:165], v185 offset:0
    ds_read_b64_tr_b16 v[166:167], v185 offset:4096
    v_mov_b32 v0, 0
    v_mov_b32 v1, 0
    v_mov_b32 v2, 0
    v_mov_b32 v3, 0
    v_mov_b32 v4, 0
    v_mov_b32 v5, 0
    v_mov_b32 v6, 0
    v_mov_b32 v7, 0
    v_mov_b32 v8, 0
    v_mov_b32 v9, 0
    v_mov_b32 v10, 0
    v_mov_b32 v11, 0
    v_mov_b32 v12, 0
    v_mov_b32 v13, 0
    v_mov_b32 v14, 0
    v_mov_b32 v15, 0
    v_mov_b32 v16, 0
    v_mov_b32 v17, 0
    v_mov_b32 v18, 0
    v_mov_b32 v19, 0
    v_mov_b32 v20, 0
    v_mov_b32 v21, 0
    v_mov_b32 v22, 0
    v_mov_b32 v23, 0
    v_mov_b32 v24, 0
    v_mov_b32 v25, 0
    v_mov_b32 v26, 0
    v_mov_b32 v27, 0
    v_mov_b32 v28, 0
    v_mov_b32 v29, 0
    v_mov_b32 v30, 0
    v_mov_b32 v31, 0
    v_mov_b32 v32, 0
    v_mov_b32 v33, 0
    v_mov_b32 v34, 0
    v_mov_b32 v35, 0
    v_mov_b32 v36, 0
    v_mov_b32 v37, 0
    v_mov_b32 v38, 0
    v_mov_b32 v39, 0
    v_mov_b32 v40, 0
    v_mov_b32 v41, 0
    v_mov_b32 v42, 0
    v_mov_b32 v43, 0
    v_mov_b32 v44, 0
    v_mov_b32 v45, 0
    v_mov_b32 v46, 0
    v_mov_b32 v47, 0
    v_mov_b32 v48, 0
    v_mov_b32 v49, 0
    v_mov_b32 v50, 0
    v_mov_b32 v51, 0
    v_mov_b32 v52, 0
    v_mov_b32 v53, 0
    v_mov_b32 v54, 0
    v_mov_b32 v55, 0
    v_mov_b32 v56, 0
    v_mov_b32 v57, 0
    v_mov_b32 v58, 0
    v_mov_b32 v59, 0
    v_mov_b32 v60, 0
    v_mov_b32 v61, 0
    v_mov_b32 v62, 0
    v_mov_b32 v63, 0
    v_mov_b32 v64, 0
    v_mov_b32 v65, 0
    v_mov_b32 v66, 0
    v_mov_b32 v67, 0
    v_mov_b32 v68, 0
    v_mov_b32 v69, 0
    v_mov_b32 v70, 0
    v_mov_b32 v71, 0
    s_waitcnt vmcnt(4)
    s_waitcnt lgkmcnt(10)
    v_add_u32 v186, s32, v186
    ds_read_b64_tr_b16 v[168:169], v186 offset:0
    ds_read_b64_tr_b16 v[170:171], v186 offset:4096
    v_mfma_f32_16x16x32_bf16 v[0:3], v[144:147], v[72:75], v[0:3]
    v_mfma_f32_16x16x32_bf16 v[4:7], v[144:147], v[76:79], v[4:7]
    buffer_load_dwordx4 v[96:99], v193, s[12:15], s36 offen offset:0 sc1
    s_waitcnt lgkmcnt(10)
    v_add_u32 v187, s32, v187
    ds_read_b64_tr_b16 v[172:173], v187 offset:0
    ds_read_b64_tr_b16 v[174:175], v187 offset:4096
    v_mfma_f32_16x16x32_bf16 v[8:11], v[148:151], v[72:75], v[8:11]
    v_mfma_f32_16x16x32_bf16 v[12:15], v[148:151], v[76:79], v[12:15]
    buffer_load_dwordx4 v[100:103], v193, s[12:15], s36 offen offset:1024 sc1
    s_add_u32 s36, s36, 0x20000
    s_waitcnt lgkmcnt(10)
    v_add_u32 v188, s32, v188
    ds_read_b64_tr_b16 v[176:177], v188 offset:0
    ds_read_b64_tr_b16 v[178:179], v188 offset:512
    v_mfma_f32_16x16x32_bf16 v[16:19], v[152:155], v[72:75], v[16:19]
    v_mfma_f32_16x16x32_bf16 v[20:23], v[152:155], v[76:79], v[20:23]
    buffer_load_dwordx4 v[104:107], v193, s[12:15], s36 offen offset:0 sc1
    s_waitcnt lgkmcnt(10)
    ds_read_b64_tr_b16 v[144:145], v180 offset:8192
    ds_read_b64_tr_b16 v[146:147], v180 offset:12288
    v_mfma_f32_16x16x32_bf16 v[24:27], v[156:159], v[72:75], v[24:27]
    v_mfma_f32_16x16x32_bf16 v[28:31], v[156:159], v[76:79], v[28:31]
    buffer_load_dwordx4 v[108:111], v193, s[12:15], s36 offen offset:1024 sc1
    s_add_u32 s36, s36, 0x20000
    s_waitcnt lgkmcnt(10)
    ds_read_b64_tr_b16 v[148:149], v181 offset:8192
    ds_read_b64_tr_b16 v[150:151], v181 offset:12288
    v_mfma_f32_16x16x32_bf16 v[32:35], v[160:163], v[72:75], v[32:35]
    v_mfma_f32_16x16x32_bf16 v[36:39], v[160:163], v[76:79], v[36:39]
    s_waitcnt lgkmcnt(10)
    ds_read_b64_tr_b16 v[152:153], v182 offset:8192
    ds_read_b64_tr_b16 v[154:155], v182 offset:12288
    v_mfma_f32_16x16x32_bf16 v[40:43], v[164:167], v[72:75], v[40:43]
    v_mfma_f32_16x16x32_bf16 v[44:47], v[164:167], v[76:79], v[44:47]
    s_waitcnt lgkmcnt(10)
    ds_read_b64_tr_b16 v[156:157], v183 offset:8192
    ds_read_b64_tr_b16 v[158:159], v183 offset:12288
    v_mfma_f32_16x16x32_bf16 v[48:51], v[168:171], v[72:75], v[48:51]
    v_mfma_f32_16x16x32_bf16 v[52:55], v[168:171], v[76:79], v[52:55]
    s_waitcnt lgkmcnt(10)
    ds_read_b64_tr_b16 v[160:161], v184 offset:8192
    ds_read_b64_tr_b16 v[162:163], v184 offset:12288
    v_mfma_f32_16x16x32_bf16 v[56:59], v[172:175], v[72:75], v[56:59]
    v_mfma_f32_16x16x32_bf16 v[60:63], v[172:175], v[76:79], v[60:63]
    s_waitcnt lgkmcnt(10)
    ds_read_b64_tr_b16 v[164:165], v185 offset:8192
    ds_read_b64_tr_b16 v[166:167], v185 offset:12288
    v_mfma_f32_16x16x32_bf16 v[64:67], v[176:179], v[72:75], v[64:67]
    v_mfma_f32_16x16x32_bf16 v[68:71], v[176:179], v[76:79], v[68:71]
    s_waitcnt vmcnt(6)
    s_waitcnt lgkmcnt(10)
    ds_read_b64_tr_b16 v[168:169], v186 offset:8192
    ds_read_b64_tr_b16 v[170:171], v186 offset:12288
    v_mfma_f32_16x16x32_bf16 v[0:3], v[144:147], v[80:83], v[0:3]
    v_mfma_f32_16x16x32_bf16 v[4:7], v[144:147], v[84:87], v[4:7]
    buffer_load_dwordx4 v[112:115], v193, s[12:15], s36 offen offset:0 sc1
    s_waitcnt lgkmcnt(10)
    ds_read_b64_tr_b16 v[172:173], v187 offset:8192
    ds_read_b64_tr_b16 v[174:175], v187 offset:12288
    v_mfma_f32_16x16x32_bf16 v[8:11], v[148:151], v[80:83], v[8:11]
    v_mfma_f32_16x16x32_bf16 v[12:15], v[148:151], v[84:87], v[12:15]
    buffer_load_dwordx4 v[116:119], v193, s[12:15], s36 offen offset:1024 sc1
    s_add_u32 s36, s36, 0x20000
    s_waitcnt lgkmcnt(10)
    ds_read_b64_tr_b16 v[176:177], v188 offset:1024
    ds_read_b64_tr_b16 v[178:179], v188 offset:1536
    v_mfma_f32_16x16x32_bf16 v[16:19], v[152:155], v[80:83], v[16:19]
    v_mfma_f32_16x16x32_bf16 v[20:23], v[152:155], v[84:87], v[20:23]
    buffer_load_dwordx4 v[72:75], v193, s[12:15], s36 offen offset:0 sc1
    s_waitcnt lgkmcnt(10)
    ds_read_b64_tr_b16 v[144:145], v180 offset:16384
    ds_read_b64_tr_b16 v[146:147], v180 offset:20480
    v_mfma_f32_16x16x32_bf16 v[24:27], v[156:159], v[80:83], v[24:27]
    v_mfma_f32_16x16x32_bf16 v[28:31], v[156:159], v[84:87], v[28:31]
    buffer_load_dwordx4 v[76:79], v193, s[12:15], s36 offen offset:1024 sc1
    s_add_u32 s36, s36, 0x20000
    s_waitcnt lgkmcnt(10)
    ds_read_b64_tr_b16 v[148:149], v181 offset:16384
    ds_read_b64_tr_b16 v[150:151], v181 offset:20480
    v_mfma_f32_16x16x32_bf16 v[32:35], v[160:163], v[80:83], v[32:35]
    v_mfma_f32_16x16x32_bf16 v[36:39], v[160:163], v[84:87], v[36:39]
    s_waitcnt lgkmcnt(10)
    ds_read_b64_tr_b16 v[152:153], v182 offset:16384
    ds_read_b64_tr_b16 v[154:155], v182 offset:20480
    v_mfma_f32_16x16x32_bf16 v[40:43], v[164:167], v[80:83], v[40:43]
    v_mfma_f32_16x16x32_bf16 v[44:47], v[164:167], v[84:87], v[44:47]
    s_waitcnt lgkmcnt(10)
    ds_read_b64_tr_b16 v[156:157], v183 offset:16384
    ds_read_b64_tr_b16 v[158:159], v183 offset:20480
    v_mfma_f32_16x16x32_bf16 v[48:51], v[168:171], v[80:83], v[48:51]
    v_mfma_f32_16x16x32_bf16 v[52:55], v[168:171], v[84:87], v[52:55]
    s_waitcnt lgkmcnt(10)
    ds_read_b64_tr_b16 v[160:161], v184 offset:16384
    ds_read_b64_tr_b16 v[162:163], v184 offset:20480
    v_mfma_f32_16x16x32_bf16 v[56:59], v[172:175], v[80:83], v[56:59]
    v_mfma_f32_16x16x32_bf16 v[60:63], v[172:175], v[84:87], v[60:63]
    s_waitcnt lgkmcnt(10)
    ds_read_b64_tr_b16 v[164:165], v185 offset:16384
    ds_read_b64_tr_b16 v[166:167], v185 offset:20480
    v_mfma_f32_16x16x32_bf16 v[64:67], v[176:179], v[80:83], v[64:67]
    v_mfma_f32_16x16x32_bf16 v[68:71], v[176:179], v[84:87], v[68:71]
    s_waitcnt vmcnt(8)
    s_add_u32 s33, s33, 27648
    s_cmp_ge_u32 s33, 110592
    s_cselect_b32 s32, 110592, 0
    s_sub_u32 s33, s33, s32
    s_sub_u32 s32, 27648, s32
    s_waitcnt lgkmcnt(10)
    ds_read_b64_tr_b16 v[168:169], v186 offset:16384
    ds_read_b64_tr_b16 v[170:171], v186 offset:20480
    v_mfma_f32_16x16x32_bf16 v[0:3], v[144:147], v[88:91], v[0:3]
    v_mfma_f32_16x16x32_bf16 v[4:7], v[144:147], v[92:95], v[4:7]
    buffer_load_dwordx4 v[80:83], v193, s[12:15], s36 offen offset:0 sc1
    s_waitcnt lgkmcnt(10)
    ds_read_b64_tr_b16 v[172:173], v187 offset:16384
    ds_read_b64_tr_b16 v[174:175], v187 offset:20480
    v_mfma_f32_16x16x32_bf16 v[8:11], v[148:151], v[88:91], v[8:11]
    v_mfma_f32_16x16x32_bf16 v[12:15], v[148:151], v[92:95], v[12:15]
    buffer_load_dwordx4 v[84:87], v193, s[12:15], s36 offen offset:1024 sc1
    s_add_u32 s36, s36, 0x20000
    s_waitcnt lgkmcnt(10)
    ds_read_b64_tr_b16 v[176:177], v188 offset:2048
    ds_read_b64_tr_b16 v[178:179], v188 offset:2560
    v_mfma_f32_16x16x32_bf16 v[16:19], v[152:155], v[88:91], v[16:19]
    v_mfma_f32_16x16x32_bf16 v[20:23], v[152:155], v[92:95], v[20:23]
    s_add_u32 m0, s34, s39
    s_nop 0
    buffer_load_dwordx4 v189, s[8:11], s37 offen offset:0 lds
    s_waitcnt lgkmcnt(10)
    s_barrier
    v_add_u32 v180, s32, v180
    ds_read_b64_tr_b16 v[144:145], v180 offset:0
    ds_read_b64_tr_b16 v[146:147], v180 offset:4096
    v_mfma_f32_16x16x32_bf16 v[24:27], v[156:159], v[88:91], v[24:27]
    v_mfma_f32_16x16x32_bf16 v[28:31], v[156:159], v[92:95], v[28:31]
    s_add_u32 m0, s34, s45
    s_mov_b32 exec_lo, 0xffffff
    s_mov_b32 exec_hi, 0
    buffer_load_dwordx4 v192, s[8:11], s37 offen offset:0 lds
    s_mov_b64 exec, -1
    s_waitcnt lgkmcnt(10)
    v_add_u32 v181, s32, v181
    ds_read_b64_tr_b16 v[148:149], v181 offset:0
    ds_read_b64_tr_b16 v[150:151], v181 offset:4096
    v_mfma_f32_16x16x32_bf16 v[32:35], v[160:163], v[88:91], v[32:35]
    v_mfma_f32_16x16x32_bf16 v[36:39], v[160:163], v[92:95], v[36:39]
    s_add_u32 m0, s34, s39
    s_nop 0
    buffer_load_dwordx4 v190, s[8:11], s37 offen offset:1024 lds
    s_waitcnt lgkmcnt(10)
    v_add_u32 v182, s32, v182
    ds_read_b64_tr_b16 v[152:153], v182 offset:0
    ds_read_b64_tr_b16 v[154:155], v182 offset:4096
    v_mfma_f32_16x16x32_bf16 v[40:43], v[164:167], v[88:91], v[40:43]
    v_mfma_f32_16x16x32_bf16 v[44:47], v[164:167], v[92:95], v[44:47]
    s_add_u32 m0, s34, s39
    s_nop 0
    buffer_load_dwordx4 v191, s[8:11], s37 offen offset:2048 lds
    s_add_u32 s37, s37, 110592
    s_add_u32 s34, s34, 27648
    s_cmp_ge_u32 s34, 110592
    s_cselect_b32 s34, 0, s34
    s_waitcnt lgkmcnt(10)
    v_add_u32 v183, s32, v183
    ds_read_b64_tr_b16 v[156:157], v183 offset:0
    ds_read_b64_tr_b16 v[158:159], v183 offset:4096
    v_mfma_f32_16x16x32_bf16 v[48:51], v[168:171], v[88:91], v[48:51]
    v_mfma_f32_16x16x32_bf16 v[52:55], v[168:171], v[92:95], v[52:55]
    s_waitcnt lgkmcnt(10)
    v_add_u32 v184, s32, v184
    ds_read_b64_tr_b16 v[160:161], v184 offset:0
    ds_read_b64_tr_b16 v[162:163], v184 offset:4096
    v_mfma_f32_16x16x32_bf16 v[56:59], v[172:175], v[88:91], v[56:59]
    v_mfma_f32_16x16x32_bf16 v[60:63], v[172:175], v[92:95], v[60:63]
    s_waitcnt lgkmcnt(10)
    v_add_u32 v185, s32, v185
    ds_read_b64_tr_b16 v[164:165], v185 offset:0
    ds_read_b64_tr_b16 v[166:167], v185 offset:4096
    v_mfma_f32_16x16x32_bf16 v[64:67], v[176:179], v[88:91], v[64:67]
    v_mfma_f32_16x16x32_bf16 v[68:71], v[176:179], v[92:95], v[68:71]
K2_JOIN:
    s_waitcnt vmcnt(10)
    s_mov_b32 s31, 4
    s_branch K2_MID
K2_LOOP:
    s_waitcnt vmcnt(14)
    s_waitcnt lgkmcnt(10)
    v_add_u32 v186, s32, v186
    ds_read_b64_tr_b16 v[168:169], v186 offset:0
    ds_read_b64_tr_b16 v[170:171], v186 offset:4096
    v_mfma_f32_16x16x32_bf16 v[0:3], v[144:147], v[72:75], v[0:3]
    v_mfma_f32_16x16x32_bf16 v[4:7], v[144:147], v[76:79], v[4:7]
    buffer_load_dwordx4 v[112:115], v193, s[12:15], s36 offen offset:0 sc1
    s_waitcnt lgkmcnt(10)
    v_add_u32 v187, s32, v187
    ds_read_b64_tr_b16 v[172:173], v187 offset:0
    ds_read_b64_tr_b16 v[174:175], v187 offset:4096
    v_mfma_f32_16x16x32_bf16 v[8:11], v[148:151], v[72:75], v[8:11]
    v_mfma_f32_16x16x32_bf16 v[12:15], v[148:151], v[76:79], v[12:15]
    s_waitcnt lgkmcnt(10)
    v_add_u32 v188, s32, v188
    ds_read_b64_tr_b16 v[176:177], v188 offset:0
    ds_read_b64_tr_b16 v[178:179], v188 offset:512
    v_mfma_f32_16x16x32_bf16 v[16:19], v[152:155], v[72:75], v[16:19]
    v_mfma_f32_16x16x32_bf16 v[20:23], v[152:155], v[76:79], v[20:23]
    buffer_load_dwordx4 v[116:119], v193, s[12:15], s36 offen offset:1024 sc1
    s_add_u32 s36, s36, 0x20000
    s_waitcnt lgkmcnt(10)
    ds_read_b64_tr_b16 v[144:145], v180 offset:8192
    ds_read_b64_tr_b16 v[146:147], v180 offset:12288
    v_mfma_f32_16x16x32_bf16 v[24:27], v[156:159], v[72:75], v[24:27]
    v_mfma_f32_16x16x32_bf16 v[28:31], v[156:159], v[76:79], v[28:31]
    s_waitcnt lgkmcnt(10)
    ds_read_b64_tr_b16 v[148:149], v181 offset:8192
    ds_read_b64_tr_b16 v[150:151], v181 offset:12288
    v_mfma_f32_16x16x32_bf16 v[32:35], v[160:163], v[72:75], v[32:35]
    v_mfma_f32_16x16x32_bf16 v[36:39], v[160:163], v[76:79], v[36:39]
    s_add_u32 m0, s34, s39
    s_nop 0
    buffer_load_dwordx4 v189, s[8:11], s37 offen offset:0 lds
    s_waitcnt lgkmcnt(10)
    ds_read_b64_tr_b16 v[152:153], v182 offset:8192
    ds_read_b64_tr_b16 v[154:155], v182 offset:12288
    v_mfma_f32_16x16x32_bf16 v[40:43], v[164:167], v[72:75], v[40:43]
    v_mfma_f32_16x16x32_bf16 v[44:47], v[164:167], v[76:79], v[44:47]
    s_waitcnt lgkmcnt(10)
    ds_read_b64_tr_b16 v[156:157], v183 offset:8192
    ds_read_b64_tr_b16 v[158:159], v183 offset:12288
    v_mfma_f32_16x16x32_bf16 v[48:51], v[168:171], v[72:75], v[48:51]
    v_mfma_f32_16x16x32_bf16 v[52:55], v[168:171], v[76:79], v[52:55]
    s_add_u32 m0, s34, s45
    s_mov_b32 exec_lo, 0xffffff
    s_mov_b32 exec_hi, 0
    buffer_load_dwordx4 v192, s[8:11], s37 offen offset:0 lds
    s_mov_b64 exec, -1
    s_waitcnt lgkmcnt(10)
    ds_read_b64_tr_b16 v[160:161], v184 offset:8192
    ds_read_b64_tr_b16 v[162:163], v184 offset:12288
    v_mfma_f32_16x16x32_bf16 v[56:59], v[172:175], v[72:75], v[56:59]
    v_mfma_f32_16x16x32_bf16 v[60:63], v[172:175], v[76:79], v[60:63]
    s_waitcnt lgkmcnt(10)
    ds_read_b64_tr_b16 v[164:165], v185 offset:8192
    ds_read_b64_tr_b16 v[166:167], v185 offset:12288
    v_mfma_f32_16x16x32_bf16 v[64:67], v[176:179], v[72:75], v[64:67]
    v_mfma_f32_16x16x32_bf16 v[68:71], v[176:179], v[76:79], v[68:71]
    s_waitcnt vmcnt(15)
    s_waitcnt lgkmcnt(10)
    ds_read_b64_tr_b16 v[168:169], v186 offset:8192
    ds_read_b64_tr_b16 v[170:171], v186 offset:12288
    v_mfma_f32_16x16x32_bf16 v[0:3], v[144:147], v[80:83], v[0:3]
    v_mfma_f32_16x16x32_bf16 v[4:7], v[144:147], v[84:87], v[4:7]
    buffer_load_dwordx4 v[72:75], v193, s[12:15], s36 offen offset:0 sc1
    s_waitcnt lgkmcnt(10)
    ds_read_b64_tr_b16 v[172:173], v187 offset:8192
    ds_read_b64_tr_b16 v[174:175], v187 offset:12288
    v_mfma_f32_16x16x32_bf16 v[8:11], v[148:151], v[80:83], v[8:11]
    v_mfma_f32_16x16x32_bf16 v[12:15], v[148:151], v[84:87], v[12:15]
    s_waitcnt lgkmcnt(10)
    ds_read_b64_tr_b16 v[176:177], v188 offset:1024
    ds_read_b64_tr_b16 v[178:179], v188 offset:1536
    v_mfma_f32_16x16x32_bf16 v[16:19], v[152:155], v[80:83], v[16:19]
    v_mfma_f32_16x16x32_bf16 v[20:23], v[152:155], v[84:87], v[20:23]
    buffer_load_dwordx4 v[76:79], v193, s[12:15], s36 offen offset:1024 sc1
    s_add_u32 s36, s36, 0x20000
    s_waitcnt lgkmcnt(10)
    ds_read_b64_tr_b16 v[144:145], v180 offset:16384
    ds_read_b64_tr_b16 v[146:147], v180 offset:20480
    v_mfma_f32_16x16x32_bf16 v[24:27], v[156:159], v[80:83], v[24:27]
    v_mfma_f32_16x16x32_bf16 v[28:31], v[156:159], v[84:87], v[28:31]
    s_waitcnt lgkmcnt(10)
    ds_read_b64_tr_b16 v[148:149], v181 offset:16384
    ds_read_b64_tr_b16 v[150:151], v181 offset:20480
    v_mfma_f32_16x16x32_bf16 v[32:35], v[160:163], v[80:83], v[32:35]
    v_mfma_f32_16x16x32_bf16 v[36:39], v[160:163], v[84:87], v[36:39]
    s_add_u32 m0, s34, s39
    s_nop 0
    buffer_load_dwordx4 v190, s[8:11], s37 offen offset:1024 lds
    s_waitcnt lgkmcnt(10)
    ds_read_b64_tr_b16 v[152:153], v182 offset:16384
    ds_read_b64_tr_b16 v[154:155], v182 offset:20480
    v_mfma_f32_16x16x32_bf16 v[40:43], v[164:167], v[80:83], v[40:43]
    v_mfma_f32_16x16x32_bf16 v[44:47], v[164:167], v[84:87], v[44:47]
    s_waitcnt lgkmcnt(10)
    ds_read_b64_tr_b16 v[156:157], v183 offset:16384
    ds_read_b64_tr_b16 v[158:159], v183 offset:20480
    v_mfma_f32_16x16x32_bf16 v[48:51], v[168:171], v[80:83], v[48:51]
    v_mfma_f32_16x16x32_bf16 v[52:55], v[168:171], v[84:87], v[52:55]
    s_waitcnt lgkmcnt(10)
    ds_read_b64_tr_b16 v[160:161], v184 offset:16384
    ds_read_b64_tr_b16 v[162:163], v184 offset:20480
    v_mfma_f32_16x16x32_bf16 v[56:59], v[172:175], v[80:83], v[56:59]
    v_mfma_f32_16x16x32_bf16 v[60:63], v[172:175], v[84:87], v[60:63]
    s_waitcnt lgkmcnt(10)
    ds_read_b64_tr_b16 v[164:165], v185 offset:16384
    ds_read_b64_tr_b16 v[166:167], v185 offset:20480
    v_mfma_f32_16x16x32_bf16 v[64:67], v[176:179], v[80:83], v[64:67]
    v_mfma_f32_16x16x32_bf16 v[68:71], v[176:179], v[84:87], v[68:71]
    s_waitcnt vmcnt(15)
    s_add_u32 s33, s33, 27648
    s_cmp_ge_u32 s33, 110592
    s_cselect_b32 s32, 110592, 0
    s_sub_u32 s33, s33, s32
    s_sub_u32 s32, 27648, s32
    s_waitcnt lgkmcnt(10)
    ds_read_b64_tr_b16 v[168:169], v186 offset:16384
    ds_read_b64_tr_b16 v[170:171], v186 offset:20480
    v_mfma_f32_16x16x32_bf16 v[0:3], v[144:147], v[88:91], v[0:3]
    v_mfma_f32_16x16x32_bf16 v[4:7], v[144:147], v[92:95], v[4:7]
    buffer_load_dwordx4 v[80:83], v193, s[12:15], s36 offen offset:0 sc1
    s_waitcnt lgkmcnt(10)
    ds_read_b64_tr_b16 v[172:173], v187 offset:16384
    ds_read_b64_tr_b16 v[174:175], v187 offset:20480
    v_mfma_f32_16x16x32_bf16 v[8:11], v[148:151], v[88:91], v[8:11]
    v_mfma_f32_16x16x32_bf16 v[12:15], v[148:151], v[92:95], v[12:15]
    s_waitcnt lgkmcnt(10)
    ds_read_b64_tr_b16 v[176:177], v188 offset:2048
    ds_read_b64_tr_b16 v[178:179], v188 offset:2560
    v_mfma_f32_16x16x32_bf16 v[16:19], v[152:155], v[88:91], v[16:19]
    v_mfma_f32_16x16x32_bf16 v[20:23], v[152:155], v[92:95], v[20:23]
    buffer_load_dwordx4 v[84:87], v193, s[12:15], s36 offen offset:1024 sc1
    s_add_u32 s36, s36, 0x20000
    s_waitcnt lgkmcnt(10)
    s_barrier
    v_add_u32 v180, s32, v180
    ds_read_b64_tr_b16 v[144:145], v180 offset:0
    ds_read_b64_tr_b16 v[146:147], v180 offset:4096
    v_mfma_f32_16x16x32_bf16 v[24:27], v[156:159], v[88:91], v[24:27]
    v_mfma_f32_16x16x32_bf16 v[28:31], v[156:159], v[92:95], v[28:31]
    s_waitcnt lgkmcnt(10)
    v_add_u32 v181, s32, v181
    ds_read_b64_tr_b16 v[148:149], v181 offset:0
    ds_read_b64_tr_b16 v[150:151], v181 offset:4096
    v_mfma_f32_16x16x32_bf16 v[32:35], v[160:163], v[88:91], v[32:35]
    v_mfma_f32_16x16x32_bf16 v[36:39], v[160:163], v[92:95], v[36:39]
    s_add_u32 m0, s34, s39
    s_nop 0
    buffer_load_dwordx4 v191, s[8:11], s37 offen offset:2048 lds
    s_add_u32 s37, s37, 110592
    s_add_u32 s34, s34, 27648
    s_cmp_ge_u32 s34, 110592
    s_cselect_b32 s34, 0, s34
    s_waitcnt lgkmcnt(10)
    v_add_u32 v182, s32, v182
    ds_read_b64_tr_b16 v[152:153], v182 offset:0
    ds_read_b64_tr_b16 v[154:155], v182 offset:4096
    v_mfma_f32_16x16x32_bf16 v[40:43], v[164:167], v[88:91], v[40:43]
    v_mfma_f32_16x16x32_bf16 v[44:47], v[164:167], v[92:95], v[44:47]
    s_waitcnt lgkmcnt(10)
    v_add_u32 v183, s32, v183
    ds_read_b64_tr_b16 v[156:157], v183 offset:0
    ds_read_b64_tr_b16 v[158:159], v183 offset:4096
    v_mfma_f32_16x16x32_bf16 v[48:51], v[168:171], v[88:91], v[48:51]
    v_mfma_f32_16x16x32_bf16 v[52:55], v[168:171], v[92:95], v[52:55]
    s_waitcnt lgkmcnt(10)
    v_add_u32 v184, s32, v184
    ds_read_b64_tr_b16 v[160:161], v184 offset:0
    ds_read_b64_tr_b16 v[162:163], v184 offset:4096
    v_mfma_f32_16x16x32_bf16 v[56:59], v[172:175], v[88:91], v[56:59]
    v_mfma_f32_16x16x32_bf16 v[60:63], v[172:175], v[92:95], v[60:63]
    s_waitcnt lgkmcnt(10)
    v_add_u32 v185, s32, v185
    ds_read_b64_tr_b16 v[164:165], v185 offset:0
    ds_read_b64_tr_b16 v[166:167], v185 offset:4096
    v_mfma_f32_16x16x32_bf16 v[64:67], v[176:179], v[88:91], v[64:67]
    v_mfma_f32_16x16x32_bf16 v[68:71], v[176:179], v[92:95], v[68:71]
    s_sub_u32 s31, s31, 1
    s_cmp_lg_u32 s31, 0
    s_cbranch_scc0 K2_DONE
K2_MID:
    s_waitcnt vmcnt(14)
    s_waitcnt lgkmcnt(10)
    v_add_u32 v186, s32, v186
    ds_read_b64_tr_b16 v[168:169], v186 offset:0
    ds_read_b64_tr_b16 v[170:171], v186 offset:4096
    v_mfma_f32_16x16x32_bf16 v[0:3], v[144:147], v[96:99], v[0:3]
    v_mfma_f32_16x16x32_bf16 v[4:7], v[144:147], v[100:103], v[4:7]
    buffer_load_dwordx4 v[88:91], v193, s[12:15], s36 offen offset:0 sc1
    s_waitcnt lgkmcnt(10)
    v_add_u32 v187, s32, v187
    ds_read_b64_tr_b16 v[172:173], v187 offset:0
    ds_read_b64_tr_b16 v[174:175], v187 offset:4096
    v_mfma_f32_16x16x32_bf16 v[8:11], v[148:151], v[96:99], v[8:11]
    v_mfma_f32_16x16x32_bf16 v[12:15], v[148:151], v[100:103], v[12:15]
    s_waitcnt lgkmcnt(10)
    v_add_u32 v188, s32, v188
    ds_read_b64_tr_b16 v[176:177], v188 offset:0
    ds_read_b64_tr_b16 v[178:179], v188 offset:512
    v_mfma_f32_16x16x32_bf16 v[16:19], v[152:155], v[96:99], v[16:19]
    v_mfma_f32_16x16x32_bf16 v[20:23], v[152:155], v[100:103], v[20:23]
    buffer_load_dwordx4 v[92:95], v193, s[12:15], s36 offen offset:1024 sc1
    s_add_u32 s36, s36, 0x20000
    s_waitcnt lgkmcnt(10)
    ds_read_b64_tr_b16 v[144:145], v180 offset:8192
    ds_read_b64_tr_b16 v[146:147], v180 offset:12288
    v_mfma_f32_16x16x32_bf16 v[24:27], v[156:159], v[96:99], v[24:27]
    v_mfma_f32_16x16x32_bf16 v[28:31], v[156:159], v[100:103], v[28:31]
    s_waitcnt lgkmcnt(10)
    ds_read_b64_tr_b16 v[148:149], v181 offset:8192
    ds_read_b64_tr_b16 v[150:151], v181 offset:12288
    v_mfma_f32_16x16x32_bf16 v[32:35], v[160:163], v[96:99], v[32:35]
    v_mfma_f32_16x16x32_bf16 v[36:39], v[160:163], v[100:103], v[36:39]
    s_add_u32 m0, s34, s39
    s_nop 0
    buffer_load_dwordx4 v189, s[8:11], s37 offen offset:0 lds
    s_waitcnt lgkmcnt(10)
    ds_read_b64_tr_b16 v[152:153], v182 offset:8192
    ds_read_b64_tr_b16 v[154:155], v182 offset:12288
    v_mfma_f32_16x16x32_bf16 v[40:43], v[164:167], v[96:99], v[40:43]
    v_mfma_f32_16x16x32_bf16 v[44:47], v[164:167], v[100:103], v[44:47]
    s_waitcnt lgkmcnt(10)
    ds_read_b64_tr_b16 v[156:157], v183 offset:8192
    ds_read_b64_tr_b16 v[158:159], v183 offset:12288
    v_mfma_f32_16x16x32_bf16 v[48:51], v[168:171], v[96:99], v[48:51]
    v_mfma_f32_16x16x32_bf16 v[52:55], v[168:171], v[100:103], v[52:55]
    s_add_u32 m0, s34, s45
    s_mov_b32 exec_lo, 0xffffff
    s_mov_b32 exec_hi, 0
    buffer_load_dwordx4 v192, s[8:11], s37 offen offset:0 lds
    s_mov_b64 exec, -1
    s_waitcnt lgkmcnt(10)
    ds_read_b64_tr_b16 v[160:161], v184 offset:8192
    ds_read_b64_tr_b16 v[162:163], v184 offset:12288
    v_mfma_f32_16x16x32_bf16 v[56:59], v[172:175], v[96:99], v[56:59]
    v_mfma_f32_16x16x32_bf16 v[60:63], v[172:175], v[100:103], v[60:63]
    s_waitcnt lgkmcnt(10)
    ds_read_b64_tr_b16 v[164:165], v185 offset:8192
    ds_read_b64_tr_b16 v[166:167], v185 offset:12288
    v_mfma_f32_16x16x32_bf16 v[64:67], v[176:179], v[96:99], v[64:67]
    v_mfma_f32_16x16x32_bf16 v[68:71], v[176:179], v[100:103], v[68:71]
    s_waitcnt vmcnt(15)
    s_waitcnt lgkmcnt(10)
    ds_read_b64_tr_b16 v[168:169], v186 offset:8192
    ds_read_b64_tr_b16 v[170:171], v186 offset:12288
    v_mfma_f32_16x16x32_bf16 v[0:3], v[144:147], v[104:107], v[0:3]
    v_mfma_f32_16x16x32_bf16 v[4:7], v[144:147], v[108:111], v[4:7]
    buffer_load_dwordx4 v[96:99], v193, s[12:15], s36 offen offset:0 sc1
    s_waitcnt lgkmcnt(10)
    ds_read_b64_tr_b16 v[172:173], v187 offset:8192
    ds_read_b64_tr_b16 v[174:175], v187 offset:12288
    v_mfma_f32_16x16x32_bf16 v[8:11], v[148:151], v[104:107], v[8:11]
    v_mfma_f32_16x16x32_bf16 v[12:15], v[148:151], v[108:111], v[12:15]
    s_waitcnt lgkmcnt(10)
    ds_read_b64_tr_b16 v[176:177], v188 offset:1024
    ds_read_b64_tr_b16 v[178:179], v188 offset:1536
    v_mfma_f32_16x16x32_bf16 v[16:19], v[152:155], v[104:107], v[16:19]
    v_mfma_f32_16x16x32_bf16 v[20:23], v[152:155], v[108:111], v[20:23]
    buffer_load_dwordx4 v[100:103], v193, s[12:15], s36 offen offset:1024 sc1
    s_add_u32 s36, s36, 0x20000
    s_waitcnt lgkmcnt(10)
    ds_read_b64_tr_b16 v[144:145], v180 offset:16384
    ds_read_b64_tr_b16 v[146:147], v180 offset:20480
    v_mfma_f32_16x16x32_bf16 v[24:27], v[156:159], v[104:107], v[24:27]
    v_mfma_f32_16x16x32_bf16 v[28:31], v[156:159], v[108:111], v[28:31]
    s_waitcnt lgkmcnt(10)
    ds_read_b64_tr_b16 v[148:149], v181 offset:16384
    ds_read_b64_tr_b16 v[150:151], v181 offset:20480
    v_mfma_f32_16x16x32_bf16 v[32:35], v[160:163], v[104:107], v[32:35]
    v_mfma_f32_16x16x32_bf16 v[36:39], v[160:163], v[108:111], v[36:39]
    s_add_u32 m0, s34, s39
    s_nop 0
    buffer_load_dwordx4 v190, s[8:11], s37 offen offset:1024 lds
    s_waitcnt lgkmcnt(10)
    ds_read_b64_tr_b16 v[152:153], v182 offset:16384
    ds_read_b64_tr_b16 v[154:155], v182 offset:20480
    v_mfma_f32_16x16x32_bf16 v[40:43], v[164:167], v[104:107], v[40:43]
    v_mfma_f32_16x16x32_bf16 v[44:47], v[164:167], v[108:111], v[44:47]
    s_waitcnt lgkmcnt(10)
    ds_read_b64_tr_b16 v[156:157], v183 offset:16384
    ds_read_b64_tr_b16 v[158:159], v183 offset:20480
    v_mfma_f32_16x16x32_bf16 v[48:51], v[168:171], v[104:107], v[48:51]
    v_mfma_f32_16x16x32_bf16 v[52:55], v[168:171], v[108:111], v[52:55]
    s_waitcnt lgkmcnt(10)
    ds_read_b64_tr_b16 v[160:161], v184 offset:16384
    ds_read_b64_tr_b16 v[162:163], v184 offset:20480
    v_mfma_f32_16x16x32_bf16 v[56:59], v[172:175], v[104:107], v[56:59]
    v_mfma_f32_16x16x32_bf16 v[60:63], v[172:175], v[108:111], v[60:63]
    s_waitcnt lgkmcnt(10)
    ds_read_b64_tr_b16 v[164:165], v185 offset:16384
    ds_read_b64_tr_b16 v[166:167], v185 offset:20480
    v_mfma_f32_16x16x32_bf16 v[64:67], v[176:179], v[104:107], v[64:67]
    v_mfma_f32_16x16x32_bf16 v[68:71], v[176:179], v[108:111], v[68:71]
    s_waitcnt vmcnt(15)
    s_add_u32 s33, s33, 27648
    s_cmp_ge_u32 s33, 110592
    s_cselect_b32 s32, 110592, 0
    s_sub_u32 s33, s33, s32
    s_sub_u32 s32, 27648, s32
    s_waitcnt lgkmcnt(10)
    ds_read_b64_tr_b16 v[168:169], v186 offset:16384
    ds_read_b64_tr_b16 v[170:171], v186 offset:20480
    v_mfma_f32_16x16x32_bf16 v[0:3], v[144:147], v[112:115], v[0:3]
    v_mfma_f32_16x16x32_bf16 v[4:7], v[144:147], v[116:119], v[4:7]
    buffer_load_dwordx4 v[104:107], v193, s[12:15], s36 offen offset:0 sc1
    s_waitcnt lgkmcnt(10)
    ds_read_b64_tr_b16 v[172:173], v187 offset:16384
    ds_read_b64_tr_b16 v[174:175], v187 offset:20480
    v_mfma_f32_16x16x32_bf16 v[8:11], v[148:151], v[112:115], v[8:11]
    v_mfma_f32_16x16x32_bf16 v[12:15], v[148:151], v[116:119], v[12:15]
    s_waitcnt lgkmcnt(10)
    ds_read_b64_tr_b16 v[176:177], v188 offset:2048
    ds_read_b64_tr_b16 v[178:179], v188 offset:2560
    v_mfma_f32_16x16x32_bf16 v[16:19], v[152:155], v[112:115], v[16:19]
    v_mfma_f32_16x16x32_bf16 v[20:23], v[152:155], v[116:119], v[20:23]
    buffer_load_dwordx4 v[108:111], v193, s[12:15], s36 offen offset:1024 sc1
    s_add_u32 s36, s36, 0x20000
    s_waitcnt lgkmcnt(10)
    s_barrier
    v_add_u32 v180, s32, v180
    ds_read_b64_tr_b16 v[144:145], v180 offset:0
    ds_read_b64_tr_b16 v[146:147], v180 offset:4096
    v_mfma_f32_16x16x32_bf16 v[24:27], v[156:159], v[112:115], v[24:27]
    v_mfma_f32_16x16x32_bf16 v[28:31], v[156:159], v[116:119], v[28:31]
    s_waitcnt lgkmcnt(10)
    v_add_u32 v181, s32, v181
    ds_read_b64_tr_b16 v[148:149], v181 offset:0
    ds_read_b64_tr_b16 v[150:151], v181 offset:4096
    v_mfma_f32_16x16x32_bf16 v[32:35], v[160:163], v[112:115], v[32:35]
    v_mfma_f32_16x16x32_bf16 v[36:39], v[160:163], v[116:119], v[36:39]
    s_add_u32 m0, s34, s39
    s_nop 0
    buffer_load_dwordx4 v191, s[8:11], s37 offen offset:2048 lds
    s_add_u32 s37, s37, 110592
    s_add_u32 s34, s34, 27648
    s_cmp_ge_u32 s34, 110592
    s_cselect_b32 s34, 0, s34
    s_waitcnt lgkmcnt(10)
    v_add_u32 v182, s32, v182
    ds_read_b64_tr_b16 v[152:153], v182 offset:0
    ds_read_b64_tr_b16 v[154:155], v182 offset:4096
    v_mfma_f32_16x16x32_bf16 v[40:43], v[164:167], v[112:115], v[40:43]
    v_mfma_f32_16x16x32_bf16 v[44:47], v[164:167], v[116:119], v[44:47]
    s_waitcnt lgkmcnt(10)
    v_add_u32 v183, s32, v183
    ds_read_b64_tr_b16 v[156:157], v183 offset:0
    ds_read_b64_tr_b16 v[158:159], v183 offset:4096
    v_mfma_f32_16x16x32_bf16 v[48:51], v[168:171], v[112:115], v[48:51]
    v_mfma_f32_16x16x32_bf16 v[52:55], v[168:171], v[116:119], v[52:55]
    s_waitcnt lgkmcnt(10)
    v_add_u32 v184, s32, v184
    ds_read_b64_tr_b16 v[160:161], v184 offset:0
    ds_read_b64_tr_b16 v[162:163], v184 offset:4096
    v_mfma_f32_16x16x32_bf16 v[56:59], v[172:175], v[112:115], v[56:59]
    v_mfma_f32_16x16x32_bf16 v[60:63], v[172:175], v[116:119], v[60:63]
    s_waitcnt lgkmcnt(10)
    v_add_u32 v185, s32, v185
    ds_read_b64_tr_b16 v[164:165], v185 offset:0
    ds_read_b64_tr_b16 v[166:167], v185 offset:4096
    v_mfma_f32_16x16x32_bf16 v[64:67], v[176:179], v[112:115], v[64:67]
    v_mfma_f32_16x16x32_bf16 v[68:71], v[176:179], v[116:119], v[68:71]
    s_sub_u32 s31, s31, 1
    s_cmp_lg_u32 s31, 0
    s_cbranch_scc1 K2_LOOP
K2_DONE:
    s_waitcnt vmcnt(14)
    s_waitcnt lgkmcnt(10)
    v_add_u32 v186, s32, v186
    ds_read_b64_tr_b16 v[168:169], v186 offset:0
    ds_read_b64_tr_b16 v[170:171], v186 offset:4096
    v_mfma_f32_16x16x32_bf16 v[0:3], v[144:147], v[96:99], v[0:3]
    v_mfma_f32_16x16x32_bf16 v[4:7], v[144:147], v[100:103], v[4:7]
    buffer_load_dwordx4 v[88:91], v193, s[12:15], s36 offen offset:0 sc1
    s_waitcnt lgkmcnt(10)
    v_add_u32 v187, s32, v187
    ds_read_b64_tr_b16 v[172:173], v187 offset:0
    ds_read_b64_tr_b16 v[174:175], v187 offset:4096
    v_mfma_f32_16x16x32_bf16 v[8:11], v[148:151], v[96:99], v[8:11]
    v_mfma_f32_16x16x32_bf16 v[12:15], v[148:151], v[100:103], v[12:15]
    buffer_load_dwordx4 v[92:95], v193, s[12:15], s36 offen offset:1024 sc1
    s_add_u32 s36, s36, 0x20000
    s_waitcnt lgkmcnt(10)
    v_add_u32 v188, s32, v188
    ds_read_b64_tr_b16 v[176:177], v188 offset:0
    ds_read_b64_tr_b16 v[178:179], v188 offset:512
    v_mfma_f32_16x16x32_bf16 v[16:19], v[152:155], v[96:99], v[16:19]
    v_mfma_f32_16x16x32_bf16 v[20:23], v[152:155], v[100:103], v[20:23]
    s_lshl_b32 s40, s30, 3
    s_add_u32 s40, s40, s28
    s_mul_i32 s40, s40, 36
    s_mul_i32 s41, s46, 9
    s_add_u32 s40, s40, s41
    s_lshl_b32 s40, s40, 10
    s_mul_i32 s41, s51, 2359296
    s_add_u32 s40, s40, s41
    s_and_b32 s41, s46, 1
    s_lshl_b32 s42, s41, 10
    s_add_u32 s42, s42, s40
    s_add_u32 s43, s42, 4096
    s_xor_b32 s41, s41, 1
    s_lshl_b32 s41, s41, 13
    s_add_u32 s41, s41, s40
    v_lshlrev_b32 v200, 4, v226
    v_mov_b32 v212, 40960
    v_mov_b32 v213, 0
    ds_write_b32 v212, v213
    s_sub_u32 s44, s42, s40
    v_add_u32 v208, s44, v200
    s_sub_u32 s44, s41, s40
    v_add_u32 v209, s44, v200
    s_cmp_eq_u32 s28, s51
    s_cmov_b32 s41, 0x40000000
    s_cmov_b32 s42, 0x40000000
    s_cmov_b32 s43, 0x40000000
    s_waitcnt lgkmcnt(10)
    ds_read_b64_tr_b16 v[144:145], v180 offset:8192
    ds_read_b64_tr_b16 v[146:147], v180 offset:12288
    v_mfma_f32_16x16x32_bf16 v[24:27], v[156:159], v[96:99], v[24:27]
    v_mfma_f32_16x16x32_bf16 v[28:31], v[156:159], v[100:103], v[28:31]
    s_waitcnt lgkmcnt(10)
    ds_read_b64_tr_b16 v[148:149], v181 offset:8192
    ds_read_b64_tr_b16 v[150:151], v181 offset:12288
    v_mfma_f32_16x16x32_bf16 v[32:35], v[160:163], v[96:99], v[32:35]
    v_mfma_f32_16x16x32_bf16 v[36:39], v[160:163], v[100:103], v[36:39]
    s_waitcnt lgkmcnt(10)
    ds_read_b64_tr_b16 v[152:153], v182 offset:8192
    ds_read_b64_tr_b16 v[154:155], v182 offset:12288
    v_mfma_f32_16x16x32_bf16 v[40:43], v[164:167], v[96:99], v[40:43]
    v_mfma_f32_16x16x32_bf16 v[44:47], v[164:167], v[100:103], v[44:47]
    s_waitcnt lgkmcnt(10)
    ds_read_b64_tr_b16 v[156:157], v180 offset:16384
    ds_read_b64_tr_b16 v[158:159], v180 offset:20480
    v_mfma_f32_16x16x32_bf16 v[48:51], v[168:171], v[96:99], v[48:51]
    v_mfma_f32_16x16x32_bf16 v[52:55], v[168:171], v[100:103], v[52:55]
    s_waitcnt lgkmcnt(10)
    ds_read_b64_tr_b16 v[160:161], v181 offset:16384
    ds_read_b64_tr_b16 v[162:163], v181 offset:20480
    v_mfma_f32_16x16x32_bf16 v[56:59], v[172:175], v[96:99], v[56:59]
    v_mfma_f32_16x16x32_bf16 v[60:63], v[172:175], v[100:103], v[60:63]
    s_waitcnt lgkmcnt(10)
    ds_read_b64_tr_b16 v[164:165], v182 offset:16384
    ds_read_b64_tr_b16 v[166:167], v182 offset:20480
    v_mfma_f32_16x16x32_bf16 v[64:67], v[176:179], v[96:99], v[64:67]
    v_mfma_f32_16x16x32_bf16 v[68:71], v[176:179], v[100:103], v[68:71]
    s_waitcnt vmcnt(13)
    s_waitcnt lgkmcnt(10)
    s_add_u32 s33, s33, 27648
    s_cmp_ge_u32 s33, 110592
    s_cselect_b32 s32, 110592, 0
    s_sub_u32 s33, s33, s32
    s_sub_u32 s32, 27648, s32
    s_waitcnt vmcnt(12)
    s_barrier
    v_add_u32 v180, s32, v180
    ds_read_b64_tr_b16 v[168:169], v180 offset:0
    ds_read_b64_tr_b16 v[170:171], v180 offset:4096
    v_mfma_f32_16x16x32_bf16 v[0:3], v[144:147], v[104:107], v[0:3]
    v_mfma_f32_16x16x32_bf16 v[4:7], v[144:147], v[108:111], v[4:7]
    s_waitcnt lgkmcnt(10)
    v_add_u32 v181, s32, v181
    ds_read_b64_tr_b16 v[172:173], v181 offset:0
    ds_read_b64_tr_b16 v[174:175], v181 offset:4096
    v_mfma_f32_16x16x32_bf16 v[8:11], v[148:151], v[104:107], v[8:11]
    v_mfma_f32_16x16x32_bf16 v[12:15], v[148:151], v[108:111], v[12:15]
    s_waitcnt lgkmcnt(10)
    v_add_u32 v182, s32, v182
    ds_read_b64_tr_b16 v[176:177], v182 offset:0
    ds_read_b64_tr_b16 v[178:179], v182 offset:4096
    v_mfma_f32_16x16x32_bf16 v[16:19], v[152:155], v[104:107], v[16:19]
    v_mfma_f32_16x16x32_bf16 v[20:23], v[152:155], v[108:111], v[20:23]
    s_waitcnt vmcnt(10)
    s_waitcnt lgkmcnt(10)
    ds_read_b64_tr_b16 v[144:145], v180 offset:8192
    ds_read_b64_tr_b16 v[146:147], v180 offset:12288
    v_mfma_f32_16x16x32_bf16 v[0:3], v[156:159], v[112:115], v[0:3]
    v_mfma_f32_16x16x32_bf16 v[4:7], v[156:159], v[116:119], v[4:7]
    s_waitcnt lgkmcnt(10)
    ds_read_b64_tr_b16 v[148:149], v181 offset:8192
    ds_read_b64_tr_b16 v[150:151], v181 offset:12288
    v_mfma_f32_16x16x32_bf16 v[8:11], v[160:163], v[112:115], v[8:11]
    v_mfma_f32_16x16x32_bf16 v[12:15], v[160:163], v[116:119], v[12:15]
    s_waitcnt lgkmcnt(10)
    ds_read_b64_tr_b16 v[152:153], v182 offset:8192
    ds_read_b64_tr_b16 v[154:155], v182 offset:12288
    v_mfma_f32_16x16x32_bf16 v[16:19], v[164:167], v[112:115], v[16:19]
    v_mfma_f32_16x16x32_bf16 v[20:23], v[164:167], v[116:119], v[20:23]
    s_waitcnt vmcnt(6)
    s_waitcnt lgkmcnt(10)
    ds_read_b64_tr_b16 v[156:157], v180 offset:16384
    ds_read_b64_tr_b16 v[158:159], v180 offset:20480
    v_mfma_f32_16x16x32_bf16 v[0:3], v[168:171], v[72:75], v[0:3]
    v_mfma_f32_16x16x32_bf16 v[4:7], v[168:171], v[76:79], v[4:7]
    s_waitcnt lgkmcnt(10)
    ds_read_b64_tr_b16 v[160:161], v181 offset:16384
    ds_read_b64_tr_b16 v[162:163], v181 offset:20480
    v_mfma_f32_16x16x32_bf16 v[8:11], v[172:175], v[72:75], v[8:11]
    v_mfma_f32_16x16x32_bf16 v[12:15], v[172:175], v[76:79], v[12:15]
    s_waitcnt lgkmcnt(10)
    ds_read_b64_tr_b16 v[164:165], v182 offset:16384
    ds_read_b64_tr_b16 v[166:167], v182 offset:20480
    v_mfma_f32_16x16x32_bf16 v[16:19], v[176:179], v[72:75], v[16:19]
    v_mfma_f32_16x16x32_bf16 v[20:23], v[176:179], v[76:79], v[20:23]
    s_waitcnt vmcnt(3)
    s_waitcnt lgkmcnt(10)
    ds_read_b64_tr_b16 v[168:169], v183 offset:8192
    ds_read_b64_tr_b16 v[170:171], v183 offset:12288
    v_mfma_f32_16x16x32_bf16 v[0:3], v[144:147], v[80:83], v[0:3]
    v_mfma_f32_16x16x32_bf16 v[4:7], v[144:147], v[84:87], v[4:7]
    s_waitcnt lgkmcnt(10)
    ds_read_b64_tr_b16 v[172:173], v184 offset:8192
    ds_read_b64_tr_b16 v[174:175], v184 offset:12288
    v_mfma_f32_16x16x32_bf16 v[8:11], v[148:151], v[80:83], v[8:11]
    v_mfma_f32_16x16x32_bf16 v[12:15], v[148:151], v[84:87], v[12:15]
    s_waitcnt lgkmcnt(10)
    ds_read_b64_tr_b16 v[176:177], v183 offset:16384
    ds_read_b64_tr_b16 v[178:179], v183 offset:20480
    v_mfma_f32_16x16x32_bf16 v[16:19], v[152:155], v[80:83], v[16:19]
    v_mfma_f32_16x16x32_bf16 v[20:23], v[152:155], v[84:87], v[20:23]
    s_waitcnt vmcnt(0)
    s_waitcnt lgkmcnt(10)
    ds_read_b64_tr_b16 v[144:145], v184 offset:16384
    ds_read_b64_tr_b16 v[146:147], v184 offset:20480
    v_mfma_f32_16x16x32_bf16 v[0:3], v[156:159], v[88:91], v[0:3]
    v_mfma_f32_16x16x32_bf16 v[4:7], v[156:159], v[92:95], v[4:7]
    s_waitcnt lgkmcnt(10)
    v_add_u32 v183, s32, v183
    ds_read_b64_tr_b16 v[148:149], v183 offset:0
    ds_read_b64_tr_b16 v[150:151], v183 offset:4096
    v_mfma_f32_16x16x32_bf16 v[8:11], v[160:163], v[88:91], v[8:11]
    v_mfma_f32_16x16x32_bf16 v[12:15], v[160:163], v[92:95], v[12:15]
    s_waitcnt lgkmcnt(10)
    v_add_u32 v184, s32, v184
    ds_read_b64_tr_b16 v[152:153], v184 offset:0
    ds_read_b64_tr_b16 v[154:155], v184 offset:4096
    v_mfma_f32_16x16x32_bf16 v[16:19], v[164:167], v[88:91], v[16:19]
    v_mfma_f32_16x16x32_bf16 v[20:23], v[164:167], v[92:95], v[20:23]
    s_waitcnt lgkmcnt(10)
    ds_read_b64_tr_b16 v[156:157], v183 offset:8192
    ds_read_b64_tr_b16 v[158:159], v183 offset:12288
    v_mfma_f32_16x16x32_bf16 v[24:27], v[168:171], v[104:107], v[24:27]
    v_mfma_f32_16x16x32_bf16 v[28:31], v[168:171], v[108:111], v[28:31]
    s_waitcnt lgkmcnt(10)
    ds_read_b64_tr_b16 v[160:161], v184 offset:8192
    ds_read_b64_tr_b16 v[162:163], v184 offset:12288
    v_mfma_f32_16x16x32_bf16 v[32:35], v[172:175], v[104:107], v[32:35]
    v_mfma_f32_16x16x32_bf16 v[36:39], v[172:175], v[108:111], v[36:39]
    v_cvt_pk_bf16_f32 v0, v0, v1
    v_cvt_pk_bf16_f32 v1, v2, v3
    v_cvt_pk_bf16_f32 v2, v4, v5
    v_cvt_pk_bf16_f32 v3, v6, v7
    buffer_store_dwordx4 v[0:3], v200, s[16:19], s42 offen offset:0 sc1
    v_cvt_pk_bf16_f32 v8, v8, v9
    v_cvt_pk_bf16_f32 v9, v10, v11
    v_cvt_pk_bf16_f32 v10, v12, v13
    v_cvt_pk_bf16_f32 v11, v14, v15
    buffer_store_dwordx4 v[8:11], v200, s[16:19], s42 offen offset:1024 sc1
    v_cvt_pk_bf16_f32 v16, v16, v17
    v_cvt_pk_bf16_f32 v17, v18, v19
    v_cvt_pk_bf16_f32 v18, v20, v21
    v_cvt_pk_bf16_f32 v19, v22, v23
    buffer_store_dwordx4 v[16:19], v200, s[16:19], s42 offen offset:2048 sc1
    s_cmp_lg_u32 s28, s51
    s_cbranch_scc1 K2_OWN0
    ds_write_b128 v208, v[0:3] offset:12288
    ds_write_b128 v208, v[8:11] offset:13312
    ds_write_b128 v208, v[16:19] offset:14336
K2_OWN0:
    s_waitcnt lgkmcnt(10)
    ds_read_b64_tr_b16 v[164:165], v183 offset:16384
    ds_read_b64_tr_b16 v[166:167], v183 offset:20480
    v_mfma_f32_16x16x32_bf16 v[24:27], v[176:179], v[112:115], v[24:27]
    v_mfma_f32_16x16x32_bf16 v[28:31], v[176:179], v[116:119], v[28:31]
    s_waitcnt lgkmcnt(10)
    ds_read_b64_tr_b16 v[168:169], v184 offset:16384
    ds_read_b64_tr_b16 v[170:171], v184 offset:20480
    v_mfma_f32_16x16x32_bf16 v[32:35], v[144:147], v[112:115], v[32:35]
    v_mfma_f32_16x16x32_bf16 v[36:39], v[144:147], v[116:119], v[36:39]
    s_waitcnt lgkmcnt(10)
    ds_read_b64_tr_b16 v[172:173], v185 offset:8192
    ds_read_b64_tr_b16 v[174:175], v185 offset:12288
    v_mfma_f32_16x16x32_bf16 v[24:27], v[148:151], v[72:75], v[24:27]
    v_mfma_f32_16x16x32_bf16 v[28:31], v[148:151], v[76:79], v[28:31]
    s_waitcnt lgkmcnt(10)
    ds_read_b64_tr_b16 v[176:177], v186 offset:8192
    ds_read_b64_tr_b16 v[178:179], v186 offset:12288
    v_mfma_f32_16x16x32_bf16 v[32:35], v[152:155], v[72:75], v[32:35]
    v_mfma_f32_16x16x32_bf16 v[36:39], v[152:155], v[76:79], v[36:39]
    s_waitcnt lgkmcnt(10)
    ds_read_b64_tr_b16 v[144:145], v185 offset:16384
    ds_read_b64_tr_b16 v[146:147], v185 offset:20480
    v_mfma_f32_16x16x32_bf16 v[24:27], v[156:159], v[80:83], v[24:27]
    v_mfma_f32_16x16x32_bf16 v[28:31], v[156:159], v[84:87], v[28:31]
    s_waitcnt lgkmcnt(10)
    ds_read_b64_tr_b16 v[148:149], v186 offset:16384
    ds_read_b64_tr_b16 v[150:151], v186 offset:20480
    v_mfma_f32_16x16x32_bf16 v[32:35], v[160:163], v[80:83], v[32:35]
    v_mfma_f32_16x16x32_bf16 v[36:39], v[160:163], v[84:87], v[36:39]
    s_waitcnt lgkmcnt(10)
    v_add_u32 v185, s32, v185
    ds_read_b64_tr_b16 v[152:153], v185 offset:0
    ds_read_b64_tr_b16 v[154:155], v185 offset:4096
    v_mfma_f32_16x16x32_bf16 v[24:27], v[164:167], v[88:91], v[24:27]
    v_mfma_f32_16x16x32_bf16 v[28:31], v[164:167], v[92:95], v[28:31]
    s_waitcnt lgkmcnt(10)
    v_add_u32 v186, s32, v186
    ds_read_b64_tr_b16 v[156:157], v186 offset:0
    ds_read_b64_tr_b16 v[158:159], v186 offset:4096
    v_mfma_f32_16x16x32_bf16 v[32:35], v[168:171], v[88:91], v[32:35]
    v_mfma_f32_16x16x32_bf16 v[36:39], v[168:171], v[92:95], v[36:39]
    s_waitcnt lgkmcnt(10)
    ds_read_b64_tr_b16 v[160:161], v185 offset:8192
    ds_read_b64_tr_b16 v[162:163], v185 offset:12288
    v_mfma_f32_16x16x32_bf16 v[40:43], v[172:175], v[104:107], v[40:43]
    v_mfma_f32_16x16x32_bf16 v[44:47], v[172:175], v[108:111], v[44:47]
    s_waitcnt lgkmcnt(10)
    ds_read_b64_tr_b16 v[164:165], v186 offset:8192
    ds_read_b64_tr_b16 v[166:167], v186 offset:12288
    v_mfma_f32_16x16x32_bf16 v[48:51], v[176:179], v[104:107], v[48:51]
    v_mfma_f32_16x16x32_bf16 v[52:55], v[176:179], v[108:111], v[52:55]
    v_cvt_pk_bf16_f32 v24, v24, v25
    v_cvt_pk_bf16_f32 v25, v26, v27
    v_cvt_pk_bf16_f32 v26, v28, v29
    v_cvt_pk_bf16_f32 v27, v30, v31
    buffer_store_dwordx4 v[24:27], v200, s[16:19], s42 offen offset:3072 sc1
    v_cvt_pk_bf16_f32 v32, v32, v33
    v_cvt_pk_bf16_f32 v33, v34, v35
    v_cvt_pk_bf16_f32 v34, v36, v37
    v_cvt_pk_bf16_f32 v35, v38, v39
    buffer_store_dwordx4 v[32:35], v200, s[16:19], s43 offen offset:0 sc1
    s_cmp_lg_u32 s28, s51
    s_cbranch_scc1 K2_OWN3
    ds_write_b128 v208, v[24:27] offset:15360
    ds_write_b128 v208, v[32:35] offset:16384
K2_OWN3:
    s_waitcnt lgkmcnt(10)
    ds_read_b64_tr_b16 v[168:169], v185 offset:16384
    ds_read_b64_tr_b16 v[170:171], v185 offset:20480
    v_mfma_f32_16x16x32_bf16 v[40:43], v[144:147], v[112:115], v[40:43]
    v_mfma_f32_16x16x32_bf16 v[44:47], v[144:147], v[116:119], v[44:47]
    s_waitcnt lgkmcnt(10)
    ds_read_b64_tr_b16 v[172:173], v186 offset:16384
    ds_read_b64_tr_b16 v[174:175], v186 offset:20480
    v_mfma_f32_16x16x32_bf16 v[48:51], v[148:151], v[112:115], v[48:51]
    v_mfma_f32_16x16x32_bf16 v[52:55], v[148:151], v[116:119], v[52:55]
    s_waitcnt lgkmcnt(10)
    ds_read_b64_tr_b16 v[176:177], v187 offset:8192
    ds_read_b64_tr_b16 v[178:179], v187 offset:12288
    v_mfma_f32_16x16x32_bf16 v[40:43], v[152:155], v[72:75], v[40:43]
    v_mfma_f32_16x16x32_bf16 v[44:47], v[152:155], v[76:79], v[44:47]
    s_waitcnt lgkmcnt(10)
    ds_read_b64_tr_b16 v[144:145], v188 offset:1024
    ds_read_b64_tr_b16 v[146:147], v188 offset:1536
    v_mfma_f32_16x16x32_bf16 v[48:51], v[156:159], v[72:75], v[48:51]
    v_mfma_f32_16x16x32_bf16 v[52:55], v[156:159], v[76:79], v[52:55]
    s_waitcnt lgkmcnt(10)
    ds_read_b64_tr_b16 v[148:149], v187 offset:16384
    ds_read_b64_tr_b16 v[150:151], v187 offset:20480
    v_mfma_f32_16x16x32_bf16 v[40:43], v[160:163], v[80:83], v[40:43]
    v_mfma_f32_16x16x32_bf16 v[44:47], v[160:163], v[84:87], v[44:47]
    s_waitcnt lgkmcnt(10)
    ds_read_b64_tr_b16 v[152:153], v188 offset:2048
    ds_read_b64_tr_b16 v[154:155], v188 offset:2560
    v_mfma_f32_16x16x32_bf16 v[48:51], v[164:167], v[80:83], v[48:51]
    v_mfma_f32_16x16x32_bf16 v[52:55], v[164:167], v[84:87], v[52:55]
    s_waitcnt lgkmcnt(10)
    v_add_u32 v187, s32, v187
    ds_read_b64_tr_b16 v[156:157], v187 offset:0
    ds_read_b64_tr_b16 v[158:159], v187 offset:4096
    v_mfma_f32_16x16x32_bf16 v[40:43], v[168:171], v[88:91], v[40:43]
    v_mfma_f32_16x16x32_bf16 v[44:47], v[168:171], v[92:95], v[44:47]
    s_waitcnt lgkmcnt(10)
    v_add_u32 v188, s32, v188
    ds_read_b64_tr_b16 v[160:161], v188 offset:0
    ds_read_b64_tr_b16 v[162:163], v188 offset:512
    v_mfma_f32_16x16x32_bf16 v[48:51], v[172:175], v[88:91], v[48:51]
    v_mfma_f32_16x16x32_bf16 v[52:55], v[172:175], v[92:95], v[52:55]
    s_waitcnt lgkmcnt(10)
    ds_read_b64_tr_b16 v[164:165], v187 offset:8192
    ds_read_b64_tr_b16 v[166:167], v187 offset:12288
    v_mfma_f32_16x16x32_bf16 v[56:59], v[176:179], v[104:107], v[56:59]
    v_mfma_f32_16x16x32_bf16 v[60:63], v[176:179], v[108:111], v[60:63]
    s_waitcnt lgkmcnt(10)
    ds_read_b64_tr_b16 v[168:169], v188 offset:1024
    ds_read_b64_tr_b16 v[170:171], v188 offset:1536
    v_mfma_f32_16x16x32_bf16 v[64:67], v[144:147], v[104:107], v[64:67]
    v_mfma_f32_16x16x32_bf16 v[68:71], v[144:147], v[108:111], v[68:71]
    v_cvt_pk_bf16_f32 v40, v40, v41
    v_cvt_pk_bf16_f32 v41, v42, v43
    v_cvt_pk_bf16_f32 v42, v44, v45
    v_cvt_pk_bf16_f32 v43, v46, v47
    buffer_store_dwordx4 v[40:43], v200, s[16:19], s43 offen offset:1024 sc1
    v_cvt_pk_bf16_f32 v48, v48, v49
    v_cvt_pk_bf16_f32 v49, v50, v51
    v_cvt_pk_bf16_f32 v50, v52, v53
    v_cvt_pk_bf16_f32 v51, v54, v55
    buffer_store_dwordx4 v[48:51], v200, s[16:19], s43 offen offset:2048 sc1
    s_cmp_lg_u32 s28, s51
    s_cbranch_scc1 K2_OWN5
    ds_write_b128 v208, v[40:43] offset:17408
    ds_write_b128 v208, v[48:51] offset:18432
K2_OWN5:
    s_waitcnt lgkmcnt(10)
    ds_read_b64_tr_b16 v[172:173], v187 offset:16384
    ds_read_b64_tr_b16 v[174:175], v187 offset:20480
    v_mfma_f32_16x16x32_bf16 v[56:59], v[148:151], v[112:115], v[56:59]
    v_mfma_f32_16x16x32_bf16 v[60:63], v[148:151], v[116:119], v[60:63]
    s_waitcnt lgkmcnt(10)
    ds_read_b64_tr_b16 v[176:177], v188 offset:2048
    ds_read_b64_tr_b16 v[178:179], v188 offset:2560
    v_mfma_f32_16x16x32_bf16 v[64:67], v[152:155], v[112:115], v[64:67]
    v_mfma_f32_16x16x32_bf16 v[68:71], v[152:155], v[116:119], v[68:71]
    s_waitcnt lgkmcnt(10)
    v_mfma_f32_16x16x32_bf16 v[56:59], v[156:159], v[72:75], v[56:59]
    v_mfma_f32_16x16x32_bf16 v[60:63], v[156:159], v[76:79], v[60:63]
    s_waitcnt lgkmcnt(8)
    v_mfma_f32_16x16x32_bf16 v[64:67], v[160:163], v[72:75], v[64:67]
    v_mfma_f32_16x16x32_bf16 v[68:71], v[160:163], v[76:79], v[68:71]
    s_waitcnt lgkmcnt(6)
    v_mfma_f32_16x16x32_bf16 v[56:59], v[164:167], v[80:83], v[56:59]
    v_mfma_f32_16x16x32_bf16 v[60:63], v[164:167], v[84:87], v[60:63]
    s_waitcnt lgkmcnt(4)
    v_mfma_f32_16x16x32_bf16 v[64:67], v[168:171], v[80:83], v[64:67]
    v_mfma_f32_16x16x32_bf16 v[68:71], v[168:171], v[84:87], v[68:71]
    s_waitcnt lgkmcnt(2)
    v_mfma_f32_16x16x32_bf16 v[56:59], v[172:175], v[88:91], v[56:59]
    v_mfma_f32_16x16x32_bf16 v[60:63], v[172:175], v[92:95], v[60:63]
    s_waitcnt lgkmcnt(0)
    v_mfma_f32_16x16x32_bf16 v[64:67], v[176:179], v[88:91], v[64:67]
    v_mfma_f32_16x16x32_bf16 v[68:71], v[176:179], v[92:95], v[68:71]
    s_nop 7
    s_nop 7
    v_cvt_pk_bf16_f32 v56, v56, v57
    v_cvt_pk_bf16_f32 v57, v58, v59
    v_cvt_pk_bf16_f32 v58, v60, v61
    v_cvt_pk_bf16_f32 v59, v62, v63
    buffer_store_dwordx4 v[56:59], v200, s[16:19], s43 offen offset:3072 sc1
    v_cvt_pk_bf16_f32 v64, v64, v65
    v_cvt_pk_bf16_f32 v65, v66, v67
    v_cvt_pk_bf16_f32 v66, v68, v69
    v_cvt_pk_bf16_f32 v67, v70, v71
    buffer_store_dwordx4 v[64:67], v200, s[16:19], s41 offen offset:0 sc1
    s_cmp_lg_u32 s28, s51
    s_cbranch_scc1 K2_OWN7
    ds_write_b128 v208, v[56:59] offset:19456
    ds_write_b128 v209, v[64:67] offset:12288
K2_OWN7:
    s_mov_b32 s8, s52
    s_mov_b32 s9, s53
    s_mov_b32 s10, 0x240000
    s_mov_b32 s11, 0x00020000
    s_mov_b32 s20, s60
    s_mov_b32 s21, s61
    s_mov_b32 s22, 0x240000
    s_mov_b32 s23, 0x00020000
    s_add_u32 s12, s54, 0x2b66000
    s_addc_u32 s13, s55, 0
    s_mov_b32 s14, 0x8000
    s_mov_b32 s15, 0x00020000
    s_lshl_b32 s40, s30, 3
    s_add_u32 s40, s40, s51
    s_mul_i32 s41, s40, 36864
    s_mul_i32 s42, s46, 288
    s_add_u32 s41, s41, s42
    v_add_u32 v201, 0, v229
    v_mul_u32_u24 v202, 3641, v201
    v_lshrrev_b32 v202, 16, v202
    v_mul_u32_u24 v203, 18, v202
    v_sub_u32 v203, v201, v203
    v_mul_u32_u24 v204, 1152, v202
    v_lshl_add_u32 v204, v203, 4, v204
    v_add_u32 v72, s41, v204
    v_mul_u32_u24 v204, 304, v202
    v_lshl_add_u32 v74, v203, 4, v204
    v_add_u32 v201, 512, v229
    v_mul_u32_u24 v202, 3641, v201
    v_lshrrev_b32 v202, 16, v202
    v_mul_u32_u24 v203, 18, v202
    v_sub_u32 v203, v201, v203
    v_mul_u32_u24 v204, 1152, v202
    v_lshl_add_u32 v204, v203, 4, v204
    v_add_u32 v73, s41, v204
    v_mul_u32_u24 v204, 304, v202
    v_lshl_add_u32 v75, v203, 4, v204
    s_cmp_eq_u32 s28, 0
    s_cselect_b32 s47, 0, 0x40000000
    buffer_load_dwordx4 v[76:79], v72, s[8:11], 0 offen
    buffer_load_dwordx4 v[80:83], v73, s[8:11], s47 offen
    s_mul_i32 s40, s40, 36
    s_mul_i32 s41, s46, 9
    s_add_u32 s40, s40, s41
    s_add_u32 s41, s40, s28
    s_lshl_b32 s41, s41, 10
    s_add_u32 s40, s40, 8
    s_lshl_b32 s40, s40, 10
    v_add_u32 v201, s41, v200
    v_add_u32 v202, s40, v200
    v_mul_u32_u24 v203, 304, v228
    v_lshl_add_u32 v203, v227, 3, v203
    s_lshr_b32 s40, s28, 1
    s_mul_i32 s40, s40, 4864
    s_and_b32 s41, s28, 1
    s_lshl_b32 s41, s41, 2
    s_add_u32 s40, s40, s41
    v_add_u32 v204, s40, v203
    s_lshl_b32 s40, s28, 5
    v_add_u32 v203, s40, v203
    s_mov_b32 s32, 0
    s_cmp_eq_u32 s51, 0
    s_cmov_b32 s32, 0x40000000
    s_mov_b32 s33, 2359296
    s_cmp_eq_u32 s51, 1
    s_cmov_b32 s33, 0x40000000
    s_mov_b32 s34, 4718592
    s_cmp_eq_u32 s51, 2
    s_cmov_b32 s34, 0x40000000
    s_mov_b32 s35, 7077888
    s_cmp_eq_u32 s51, 3
    s_cmov_b32 s35, 0x40000000
    s_mov_b32 s36, 9437184
    s_cmp_eq_u32 s51, 4
    s_cmov_b32 s36, 0x40000000
    s_mov_b32 s37, 11796480
    s_cmp_eq_u32 s51, 5
    s_cmov_b32 s37, 0x40000000
    s_mov_b32 s38, 14155776
    s_cmp_eq_u32 s51, 6
    s_cmov_b32 s38, 0x40000000
    s_mov_b32 s39, 16515072
    s_cmp_eq_u32 s51, 7
    s_cmov_b32 s39, 0x40000000
    s_mul_i32 s43, s28, 2359296
    s_cmp_eq_u32 s28, s51
    s_cmov_b32 s43, 0x40000000
    s_cselect_b32 s44, -1, 0
    s_cmp_eq_u32 s51, 7
    s_cselect_b32 s49, -1, 0
    s_cselect_b32 s48, 0, -1
    s_lshl_b32 s40, s28, 10
    v_add_u32 v210, s40, v200
    s_lshl_b32 s40, s28, 2
    v_add_u32 v211, s40, v200
    s_mov_b32 s45, 0xbfb8aa3b
    s_mov_b32 s46, 0xffff0000
    s_lshr_b32 s40, s2, 3
    s_lshl_b32 s40, s40, 10
    v_and_b32 v205, 7, v226
    v_lshlrev_b32 v205, 2, v205
    v_mov_b32 v206, 1
    s_lshl_b32 s41, s28, 7
    s_add_u32 s41, s41, s40
    s_lshl_b32 s42, s51, 2
    s_add_u32 s41, s41, s42
    s_lshl_b32 s42, s51, 7
    s_add_u32 s40, s40, s42
    s_waitcnt vmcnt(2)
    s_mov_b64 exec, 1
    buffer_store_dword v206, v205, s[12:15], s41 offen sc1
    s_mov_b64 exec, -1
    s_mov_b32 s42, 0
    s_mov_b32 s31, 0
    s_cmp_lg_u32 s28, 7
    s_cbranch_scc1 K2_SPIN
    s_mov_b64 exec, 0xff
K2_POLL:
    s_add_u32 s42, s42, 1
    s_sleep 8
    buffer_load_dword v215, v205, s[12:15], s40 offen sc1
    s_waitcnt vmcnt(0)
    v_cmp_eq_u32 vcc, 1, v215
    s_nop 3
    s_cmp_gt_u32 s42, 20000
    s_cselect_b32 s41, 0xff, vcc_lo
    v_mov_b32 v213, s41
    ds_write_b32 v212, v213
    s_cmp_eq_u32 s41, 0xff
    s_cbranch_scc1 K2_POLLX
    s_sleep 8
    buffer_load_dword v207, v205, s[12:15], s40 offen sc1
    s_waitcnt vmcnt(0)
    v_cmp_eq_u32 vcc, 1, v207
    s_nop 3
    s_cmp_gt_u32 s42, 20000
    s_cselect_b32 s41, 0xff, vcc_lo
    v_mov_b32 v213, s41
    ds_write_b32 v212, v213
    s_cmp_eq_u32 s41, 0xff
    s_cbranch_scc1 K2_POLLX
    s_sleep 8
    buffer_load_dword v214, v205, s[12:15], s40 offen sc1
    s_waitcnt vmcnt(0)
    v_cmp_eq_u32 vcc, 1, v214
    s_nop 3
    s_cmp_gt_u32 s42, 20000
    s_cselect_b32 s41, 0xff, vcc_lo
    v_mov_b32 v213, s41
    ds_write_b32 v212, v213
    s_cmp_eq_u32 s41, 0xff
    s_cbranch_scc1 K2_POLLX
    s_branch K2_POLL
K2_POLLX:
    s_mov_b64 exec, -1
    s_mov_b32 s42, 0xff
    s_branch K2_ISSUE
K2_SPIN:
    s_sleep 1
    ds_read_b32 v213, v212
    s_waitcnt lgkmcnt(0)
    v_readfirstlane_b32 s42, v213
    s_nop 3
    s_cmp_eq_u32 s42, s31
    s_cbranch_scc1 K2_SPIN
K2_ISSUE:
    s_andn2_b32 s41, s42, s31
    s_or_b32 s31, s31, s42
    s_bitcmp1_b32 s41, s28
    s_cbranch_scc0 K2_LT
    buffer_load_dwordx4 v[120:123], v202, s[16:19], s43 offen sc1
K2_LT:
    s_bitcmp1_b32 s41, 0
    s_cbranch_scc0 K2_L0
    buffer_load_dwordx4 v[0:3], v201, s[16:19], s32 offen sc1
K2_L0:
    s_bitcmp1_b32 s41, 1
    s_cbranch_scc0 K2_L1
    buffer_load_dwordx4 v[4:7], v201, s[16:19], s33 offen sc1
K2_L1:
    s_bitcmp1_b32 s41, 2
    s_cbranch_scc0 K2_L2
    buffer_load_dwordx4 v[8:11], v201, s[16:19], s34 offen sc1
K2_L2:
    s_bitcmp1_b32 s41, 3
    s_cbranch_scc0 K2_L3
    buffer_load_dwordx4 v[12:15], v201, s[16:19], s35 offen sc1
K2_L3:
    s_bitcmp1_b32 s41, 4
    s_cbranch_scc0 K2_L4
    buffer_load_dwordx4 v[16:19], v201, s[16:19], s36 offen sc1
K2_L4:
    s_bitcmp1_b32 s41, 5
    s_cbranch_scc0 K2_L5
    buffer_load_dwordx4 v[20:23], v201, s[16:19], s37 offen sc1
K2_L5:
    s_bitcmp1_b32 s41, 6
    s_cbranch_scc0 K2_L6
    buffer_load_dwordx4 v[24:27], v201, s[16:19], s38 offen sc1
K2_L6:
    s_bitcmp1_b32 s41, 7
    s_cbranch_scc0 K2_L7
    buffer_load_dwordx4 v[28:31], v201, s[16:19], s39 offen sc1
K2_L7:
    s_cmp_eq_u32 s31, 0xff
    s_cbranch_scc0 K2_SPIN
    s_waitcnt lgkmcnt(0)
    s_barrier
    ds_read_b128 v[116:119], v210 offset:12288
    ds_read_b128 v[124:127], v200 offset:20480
    s_waitcnt vmcnt(0) lgkmcnt(0)
    v_and_or_b32 v120, v124, s44, v120
    v_and_or_b32 v121, v125, s44, v121
    v_and_or_b32 v122, v126, s44, v122
    v_and_or_b32 v123, v127, s44, v123
    ds_write_b128 v210, v[120:123] offset:24576
    v_and_b32 v124, s48, v116
    v_and_b32 v125, s48, v117
    v_and_b32 v126, s48, v118
    v_and_b32 v127, s48, v119
    v_lshlrev_b32 v40, 16, v124
    v_and_b32 v41, s46, v124
    v_lshlrev_b32 v42, 16, v125
    v_and_b32 v43, s46, v125
    v_lshlrev_b32 v44, 16, v126
    v_and_b32 v45, s46, v126
    v_lshlrev_b32 v46, 16, v127
    v_and_b32 v47, s46, v127
    v_lshlrev_b32 v56, 16, v0
    v_and_b32 v57, s46, v0
    v_pk_add_f32 v[40:41], v[40:41], v[56:57]
    v_lshlrev_b32 v58, 16, v1
    v_and_b32 v59, s46, v1
    v_pk_add_f32 v[42:43], v[42:43], v[58:59]
    v_lshlrev_b32 v56, 16, v2
    v_and_b32 v57, s46, v2
    v_pk_add_f32 v[44:45], v[44:45], v[56:57]
    v_lshlrev_b32 v58, 16, v3
    v_and_b32 v59, s46, v3
    v_pk_add_f32 v[46:47], v[46:47], v[58:59]
    v_lshlrev_b32 v56, 16, v4
    v_and_b32 v57, s46, v4
    v_pk_add_f32 v[40:41], v[40:41], v[56:57]
    v_lshlrev_b32 v58, 16, v5
    v_and_b32 v59, s46, v5
    v_pk_add_f32 v[42:43], v[42:43], v[58:59]
    v_lshlrev_b32 v56, 16, v6
    v_and_b32 v57, s46, v6
    v_pk_add_f32 v[44:45], v[44:45], v[56:57]
    v_lshlrev_b32 v58, 16, v7
    v_and_b32 v59, s46, v7
    v_pk_add_f32 v[46:47], v[46:47], v[58:59]
    v_lshlrev_b32 v56, 16, v8
    v_and_b32 v57, s46, v8
    v_pk_add_f32 v[40:41], v[40:41], v[56:57]
    v_lshlrev_b32 v58, 16, v9
    v_and_b32 v59, s46, v9
    v_pk_add_f32 v[42:43], v[42:43], v[58:59]
    v_lshlrev_b32 v56, 16, v10
    v_and_b32 v57, s46, v10
    v_pk_add_f32 v[44:45], v[44:45], v[56:57]
    v_lshlrev_b32 v58, 16, v11
    v_and_b32 v59, s46, v11
    v_pk_add_f32 v[46:47], v[46:47], v[58:59]
    v_lshlrev_b32 v56, 16, v12
    v_and_b32 v57, s46, v12
    v_pk_add_f32 v[40:41], v[40:41], v[56:57]
    v_lshlrev_b32 v58, 16, v13
    v_and_b32 v59, s46, v13
    v_pk_add_f32 v[42:43], v[42:43], v[58:59]
    v_lshlrev_b32 v56, 16, v14
    v_and_b32 v57, s46, v14
    v_pk_add_f32 v[44:45], v[44:45], v[56:57]
    v_lshlrev_b32 v58, 16, v15
    v_and_b32 v59, s46, v15
    v_pk_add_f32 v[46:47], v[46:47], v[58:59]
    v_lshlrev_b32 v56, 16, v16
    v_and_b32 v57, s46, v16
    v_pk_add_f32 v[40:41], v[40:41], v[56:57]
    v_lshlrev_b32 v58, 16, v17
    v_and_b32 v59, s46, v17
    v_pk_add_f32 v[42:43], v[42:43], v[58:59]
    v_lshlrev_b32 v56, 16, v18
    v_and_b32 v57, s46, v18
    v_pk_add_f32 v[44:45], v[44:45], v[56:57]
    v_lshlrev_b32 v58, 16, v19
    v_and_b32 v59, s46, v19
    v_pk_add_f32 v[46:47], v[46:47], v[58:59]
    v_lshlrev_b32 v56, 16, v20
    v_and_b32 v57, s46, v20
    v_pk_add_f32 v[40:41], v[40:41], v[56:57]
    v_lshlrev_b32 v58, 16, v21
    v_and_b32 v59, s46, v21
    v_pk_add_f32 v[42:43], v[42:43], v[58:59]
    v_lshlrev_b32 v56, 16, v22
    v_and_b32 v57, s46, v22
    v_pk_add_f32 v[44:45], v[44:45], v[56:57]
    v_lshlrev_b32 v58, 16, v23
    v_and_b32 v59, s46, v23
    v_pk_add_f32 v[46:47], v[46:47], v[58:59]
    v_lshlrev_b32 v56, 16, v24
    v_and_b32 v57, s46, v24
    v_pk_add_f32 v[40:41], v[40:41], v[56:57]
    v_lshlrev_b32 v58, 16, v25
    v_and_b32 v59, s46, v25
    v_pk_add_f32 v[42:43], v[42:43], v[58:59]
    v_lshlrev_b32 v56, 16, v26
    v_and_b32 v57, s46, v26
    v_pk_add_f32 v[44:45], v[44:45], v[56:57]
    v_lshlrev_b32 v58, 16, v27
    v_and_b32 v59, s46, v27
    v_pk_add_f32 v[46:47], v[46:47], v[58:59]
    v_and_or_b32 v28, v116, s49, v28
    v_and_or_b32 v29, v117, s49, v29
    v_and_or_b32 v30, v118, s49, v30
    v_and_or_b32 v31, v119, s49, v31
    v_lshlrev_b32 v48, 16, v28
    v_and_b32 v49, s46, v28
    v_lshlrev_b32 v50, 16, v29
    v_and_b32 v51, s46, v29
    v_lshlrev_b32 v52, 16, v30
    v_and_b32 v53, s46, v30
    v_lshlrev_b32 v54, 16, v31
    v_and_b32 v55, s46, v31
    s_waitcnt lgkmcnt(0)
    s_barrier
    s_cmp_gt_u32 s28, 3
    s_cbranch_scc1 K2_NOQ0
    ds_read_b32 v32, v211 offset:24576
    ds_read_b32 v33, v211 offset:25600
    ds_read_b32 v34, v211 offset:26624
    ds_read_b32 v35, v211 offset:27648
    ds_read_b32 v36, v211 offset:28672
    ds_read_b32 v37, v211 offset:29696
    ds_read_b32 v38, v211 offset:30720
    ds_read_b32 v39, v211 offset:31744
K2_NOQ0:
    v_mul_f32 v56, s45, v40
    v_exp_f32 v56, v56
    v_mul_f32 v40, v40, v48
    v_add_f32 v56, 1.0, v56
    v_rcp_f32 v56, v56
    v_mul_f32 v57, s45, v41
    v_exp_f32 v57, v57
    v_mul_f32 v41, v41, v49
    v_add_f32 v57, 1.0, v57
    v_rcp_f32 v57, v57
    v_mul_f32 v58, s45, v42
    v_exp_f32 v58, v58
    v_mul_f32 v42, v42, v50
    v_add_f32 v58, 1.0, v58
    v_rcp_f32 v58, v58
    v_mul_f32 v59, s45, v43
    v_exp_f32 v59, v59
    v_mul_f32 v43, v43, v51
    v_add_f32 v59, 1.0, v59
    v_rcp_f32 v59, v59
    v_mul_f32 v60, s45, v44
    v_exp_f32 v60, v60
    v_mul_f32 v44, v44, v52
    v_add_f32 v60, 1.0, v60
    v_rcp_f32 v60, v60
    v_mul_f32 v61, s45, v45
    v_exp_f32 v61, v61
    v_mul_f32 v45, v45, v53
    v_add_f32 v61, 1.0, v61
    v_rcp_f32 v61, v61
    v_mul_f32 v62, s45, v46
    v_exp_f32 v62, v62
    v_mul_f32 v46, v46, v54
    v_add_f32 v62, 1.0, v62
    v_rcp_f32 v62, v62
    v_mul_f32 v63, s45, v47
    v_exp_f32 v63, v63
    v_mul_f32 v47, v47, v55
    v_add_f32 v63, 1.0, v63
    v_rcp_f32 v63, v63
    s_nop 0
    v_mul_f32 v40, v40, v56
    v_mul_f32 v41, v41, v57
    v_mul_f32 v42, v42, v58
    v_mul_f32 v43, v43, v59
    v_mul_f32 v44, v44, v60
    v_mul_f32 v45, v45, v61
    v_mul_f32 v46, v46, v62
    v_mul_f32 v47, v47, v63
    v_cvt_pk_bf16_f32 v64, v40, v41
    v_cvt_pk_bf16_f32 v65, v42, v43
    v_cvt_pk_bf16_f32 v66, v44, v45
    v_cvt_pk_bf16_f32 v67, v46, v47
    ds_write_b64 v203, v[64:65]
    ds_write_b64 v203, v[66:67] offset:4864
    s_cmp_gt_u32 s28, 3
    s_cbranch_scc1 K2_NOQ
    s_waitcnt lgkmcnt(2)
    v_lshlrev_b32 v88, 16, v32
    v_and_b32 v89, s46, v32
    v_lshlrev_b32 v104, 16, v33
    v_and_b32 v105, s46, v33
    v_pk_add_f32 v[88:89], v[88:89], v[104:105]
    v_lshlrev_b32 v104, 16, v34
    v_and_b32 v105, s46, v34
    v_pk_add_f32 v[88:89], v[88:89], v[104:105]
    v_lshlrev_b32 v104, 16, v35
    v_and_b32 v105, s46, v35
    v_pk_add_f32 v[88:89], v[88:89], v[104:105]
    v_lshlrev_b32 v104, 16, v36
    v_and_b32 v105, s46, v36
    v_pk_add_f32 v[88:89], v[88:89], v[104:105]
    v_lshlrev_b32 v104, 16, v37
    v_and_b32 v105, s46, v37
    v_pk_add_f32 v[88:89], v[88:89], v[104:105]
    v_lshlrev_b32 v104, 16, v38
    v_and_b32 v105, s46, v38
    v_pk_add_f32 v[88:89], v[88:89], v[104:105]
    v_lshlrev_b32 v96, 16, v39
    v_and_b32 v97, s46, v39
    v_mul_f32 v104, s45, v88
    v_exp_f32 v104, v104
    v_mul_f32 v88, v88, v96
    v_add_f32 v104, 1.0, v104
    v_rcp_f32 v104, v104
    v_mul_f32 v105, s45, v89
    v_exp_f32 v105, v105
    v_mul_f32 v89, v89, v97
    v_add_f32 v105, 1.0, v105
    v_rcp_f32 v105, v105
    s_nop 0
    v_mul_f32 v88, v88, v104
    v_mul_f32 v89, v89, v105
    v_cvt_pk_bf16_f32 v112, v88, v89
    ds_write_b32 v204, v112 offset:256
K2_NOQ:
    s_waitcnt lgkmcnt(0)
    s_barrier
    ds_read_b128 v[0:3], v74
    s_waitcnt lgkmcnt(0)
    v_lshlrev_b32 v8, 16, v0
    v_and_b32 v9, s46, v0
    v_lshlrev_b32 v10, 16, v76
    v_and_b32 v11, s46, v76
    v_pk_add_f32 v[8:9], v[8:9], v[10:11]
    v_cvt_pk_bf16_f32 v12, v8, v9
    v_lshlrev_b32 v8, 16, v1
    v_and_b32 v9, s46, v1
    v_lshlrev_b32 v10, 16, v77
    v_and_b32 v11, s46, v77
    v_pk_add_f32 v[8:9], v[8:9], v[10:11]
    v_cvt_pk_bf16_f32 v13, v8, v9
    v_lshlrev_b32 v8, 16, v2
    v_and_b32 v9, s46, v2
    v_lshlrev_b32 v10, 16, v78
    v_and_b32 v11, s46, v78
    v_pk_add_f32 v[8:9], v[8:9], v[10:11]
    v_cvt_pk_bf16_f32 v14, v8, v9
    v_lshlrev_b32 v8, 16, v3
    v_and_b32 v9, s46, v3
    v_lshlrev_b32 v10, 16, v79
    v_and_b32 v11, s46, v79
    v_pk_add_f32 v[8:9], v[8:9], v[10:11]
    v_cvt_pk_bf16_f32 v15, v8, v9
    buffer_store_dwordx4 v[12:15], v72, s[20:23], 0 offen
    s_cmp_lg_u32 s28, 0
    s_cbranch_scc1 K2_FIN
    ds_read_b128 v[0:3], v75
    s_waitcnt lgkmcnt(0)
    v_lshlrev_b32 v8, 16, v0
    v_and_b32 v9, s46, v0
    v_lshlrev_b32 v10, 16, v80
    v_and_b32 v11, s46, v80
    v_pk_add_f32 v[8:9], v[8:9], v[10:11]
    v_cvt_pk_bf16_f32 v16, v8, v9
    v_lshlrev_b32 v8, 16, v1
    v_and_b32 v9, s46, v1
    v_lshlrev_b32 v10, 16, v81
    v_and_b32 v11, s46, v81
    v_pk_add_f32 v[8:9], v[8:9], v[10:11]
    v_cvt_pk_bf16_f32 v17, v8, v9
    v_lshlrev_b32 v8, 16, v2
    v_and_b32 v9, s46, v2
    v_lshlrev_b32 v10, 16, v82
    v_and_b32 v11, s46, v82
    v_pk_add_f32 v[8:9], v[8:9], v[10:11]
    v_cvt_pk_bf16_f32 v18, v8, v9
    v_lshlrev_b32 v8, 16, v3
    v_and_b32 v9, s46, v3
    v_lshlrev_b32 v10, 16, v83
    v_and_b32 v11, s46, v83
    v_pk_add_f32 v[8:9], v[8:9], v[10:11]
    v_cvt_pk_bf16_f32 v19, v8, v9
    buffer_store_dwordx4 v[16:19], v73, s[20:23], 0 offen
K2_FIN:
K1_END:
    s_endpgm
K1_LAST:
.section .rodata,"a"
.p2align 6
.amdhsa_kernel k0_kernel
  .amdhsa_next_free_vgpr 80
  .amdhsa_next_free_sgpr 64
  .amdhsa_accum_offset 80
  .amdhsa_group_segment_fixed_size 0
  .amdhsa_kernarg_size 72
  .amdhsa_user_sgpr_count 2
  .amdhsa_user_sgpr_kernarg_segment_ptr 1
  .amdhsa_system_sgpr_workgroup_id_x 1
  .amdhsa_float_denorm_mode_32 3
.end_amdhsa_kernel
.p2align 6
.amdhsa_kernel k1_kernel
  .amdhsa_next_free_vgpr 256
  .amdhsa_next_free_sgpr 64
  .amdhsa_accum_offset 256
  .amdhsa_group_segment_fixed_size 0
  .amdhsa_kernarg_size 72
  .amdhsa_user_sgpr_count 2
  .amdhsa_user_sgpr_kernarg_segment_ptr 1
  .amdhsa_system_sgpr_workgroup_id_x 1
  .amdhsa_float_denorm_mode_32 3
.end_amdhsa_kernel
```
